```python
import torch

def _softmax(x, axis=-1):
    return torch.softmax(x, dim=axis)

def _gelu(x):
    return torch.nn.functional.gelu(x, approximate='tanh')

def _silu(x):
    return torch.nn.functional.silu(x)

def _sigmoid(x):
    return torch.sigmoid(x)

def _layernorm(x, axis=-1, eps=1e-05):
    m = x.mean(dim=axis, keepdim=True)
    v = x.var(dim=axis, keepdim=True, unbiased=False)
    return (x - m) / torch.sqrt(v + eps)

def _scatter_add(tgt, idx, src, axis=0):
    return tgt.clone().index_add_(axis, idx, src)

def _segment_sum(src, seg, n):
    out = torch.zeros((n,) + src.shape[1:], dtype=src.dtype)
    return out.index_add_(0, seg, src)

def _pad(x, pw):
    flat = tuple((v for pair in reversed(pw) for v in pair))
    return torch.nn.functional.pad(x, flat)
kernel_name = 'adaLN_cond__compressed_kv_cla__dense_activation_relu__decode'

def setup_inputs():

    _w = lambda a: (lambda t: t.to(torch.bfloat16) if t.is_floating_point() else t)(torch.as_tensor(a))

    def _A_setup():
        B, H, Sq, Sk, D, M = (4, 32, 1, 4096, 128, 512)
        Dc = 4 * D
        return {'x': _w((lambda *s: torch.randn(*s, dtype=torch.bfloat16) * 0.05)(B, Sq, M)), 'c_kv': _w((lambda *s: torch.randn(*s, dtype=torch.bfloat16) * 1.6)(B, Sk, Dc)), 'w_q': _w((lambda *s: torch.randn(*s, dtype=torch.bfloat16) * 1.6)(M, H, D) * M ** (-0.5)), 'w_uk': _w((lambda *s: torch.randn(*s, dtype=torch.bfloat16) * 1.6)(Dc, H, D) * Dc ** (-0.5)), 'w_uv': _w((lambda *s: torch.randn(*s, dtype=torch.bfloat16) * 1.6)(Dc, H, D) * Dc ** (-0.5)), 'w_o': _w((lambda *s: torch.randn(*s, dtype=torch.bfloat16) * 1.6)(H, D, M) * (H * D) ** (-0.5))}
    _A_in = _A_setup()

    def _B_setup():
        B, S, D, Dff = (4, 1, 512, 1376)
        return {'x': _w((lambda *s: torch.randn(*s, dtype=torch.bfloat16) * 0.05)(B, S, D)), 'w1': _w((lambda *s: torch.randn(*s, dtype=torch.bfloat16) * 0.05)(D, Dff)), 'w2': _w((lambda *s: torch.randn(*s, dtype=torch.bfloat16) * 0.05)(Dff, D))}
    _B_in = _B_setup()
    return {'A_x': _A_in['x'], 'A_c_kv': _A_in['c_kv'], 'A_w_q': _A_in['w_q'], 'A_w_uk': _A_in['w_uk'], 'A_w_uv': _A_in['w_uv'], 'A_w_o': _A_in['w_o'], 'B_x': _B_in['x'], 'B_w1': _B_in['w1'], 'B_w2': _B_in['w2'], 'c': _w((lambda *s: torch.randn(*s, dtype=torch.bfloat16) * 0.2)(4, 512) * 8.0), 'w_mod': _w((lambda *s: torch.randn(*s, dtype=torch.bfloat16) * 0.2)(512, 6 * 512) * 512 ** (-0.5) * 8.0)}

def reference(A_x, A_c_kv, A_w_q, A_w_uk, A_w_uv, A_w_o, B_x, B_w1, B_w2, c, w_mod):

    def _A_ref(x, c_kv, w_q, w_uk, w_uv, w_o):
        B, Sq, M = (x.shape[0], x.shape[1], x.shape[2])
        Sk = c_kv.shape[1]
        H, D = (w_q.shape[1], w_q.shape[2])
        q = torch.einsum('bqm,mhd->bhqd', x, w_q)
        k = torch.einsum('bkc,chd->bhkd', c_kv, w_uk)
        v = torch.einsum('bkc,chd->bhkd', c_kv, w_uv)
        scores = torch.einsum('bhqd,bhkd->bhqk', q, k) * D ** (-0.5)
        off = Sk - Sq
        qi = torch.arange(Sq)[:, None]
        kj = torch.arange(Sk)[None, :]
        cmask = kj <= qi + off
        scores = torch.where(cmask[None, None], scores, -1000000000.0)
        p = _softmax(scores, axis=-1)
        ctx = torch.einsum('bhqk,bhkd->bhqd', p, v)
        return torch.einsum('bhqd,hdm->bqm', ctx, w_o)

    def _B_ref(x, w1, w2):
        h = torch.einsum('bsd,df->bsf', x, w1)
        zero = torch.zeros_like(h)
        h = torch.maximum(h, zero)
        return torch.einsum('bsf,fd->bsd', h, w2)
    x = A_x
    mod = (_silu(c) @ w_mod).reshape(c.shape[0], 6, 1, -1)
    sa, ca, ga, sb, cb, gb = (mod[:, 0].clone(), mod[:, 1].clone(), mod[:, 2].clone(), mod[:, 3].clone(), mod[:, 4].clone(), mod[:, 5].clone())
    h = _layernorm(x, axis=-1) * (1 + ca) + sa
    x = x + ga * _A_ref(h, A_c_kv, A_w_q, A_w_uk, A_w_uv, A_w_o)
    h = _layernorm(x, axis=-1) * (1 + cb) + sb
    x = x + gb * _B_ref(h, B_w1, B_w2)
    return x
```

```asm
; @launch grid=(256,1,1) block=(512,1,1) lds=163840
.amdgcn_target "amdgcn-amd-amdhsa--gfx950"
.text
.globl adaLN_cond__compressed_kv_cla__dense_activation_relu__decode_kernel
.p2align 8
.type adaLN_cond__compressed_kv_cla__dense_activation_relu__decode_kernel,@function
adaLN_cond__compressed_kv_cla__dense_activation_relu__decode_kernel:
    s_cmp_ge_u32 s2, 256
    s_cbranch_scc1 L_end
    s_load_dwordx16 s[16:31], s[0:1], 0
    s_load_dwordx8 s[32:39], s[0:1], 64
    s_load_dwordx4 s[40:43], s[0:1], 96
    v_lshrrev_b32 v5, 6, v0
    v_and_b32 v1, 63, v0
    v_readfirstlane_b32 s5, v5
    v_lshrrev_b32 v2, 4, v1
    v_and_b32 v3, 15, v1
    v_and_b32 v4, 3, v1
    s_and_b32 s3, s2, 7
    s_lshr_b32 s4, s2, 3
    s_lshl_b32 s52, s5, 14
    s_mov_b32 s60, 0x000f000f
    s_mov_b32 s61, 0x000f000f
    s_lshl_b32 s64, s3, 4
    s_and_b32 s53, s4, 15
    s_add_u32 s64, s64, s53
    s_lshr_b32 s65, s64, 5
    s_and_b32 s66, s64, 31
    s_lshr_b32 s67, s4, 4
    s_xor_b32 s67, s67, 1
    s_lshl_b32 s64, s64, 17
    s_cmp_lg_u32 s4, 31
    s_cbranch_scc1 L_nocpf_1
    s_cmp_ge_u32 s5, 3
    s_cbranch_scc1 L_nocpf_1
    s_getpc_b64 s[62:63]
L_pc:
    s_sub_u32 s62, s62, L_pc-adaLN_cond__compressed_kv_cla__dense_activation_relu__decode_kernel
    s_subb_u32 s63, s63, 0
    v_lshlrev_b32 v5, 7, v1
    s_lshl_b32 s53, s5, 13
    v_add_u32 v5, s53, v5
    s_mov_b32 s53, L_end-adaLN_cond__compressed_kv_cla__dense_activation_relu__decode_kernel
    v_cmp_gt_u32 vcc, s53, v5
    s_nop 0
    s_and_saveexec_b64 s[100:101], vcc
    s_cbranch_execz L_cpf_skip
    global_load_dword v255, v5, s[62:63]
L_cpf_skip:
    s_mov_b64 exec, s[100:101]
L_nocpf_1:
    s_cmp_lt_u32 s4, 16
    s_cbranch_scc1 L_qpre
    s_sub_u32 s68, s4, 16
    s_cmp_ge_u32 s68, 4
    s_cbranch_scc1 L_nohp_2
    v_lshrrev_b32 v6, 3, v1
    v_mul_u32_u24 v6, 6144, v6
    v_and_b32 v7, 7, v1
    v_lshlrev_b32 v8, 1, v2
    v_xor_b32 v7, v7, v8
    v_lshl_add_u32 v6, v7, 4, v6
    v_add_u32 v7, 48128, v6
    v_add_u32 v8, 96256, v6
    v_add_u32 v9, 144384, v6
    s_lshl_b32 s53, s68, 2
    s_and_b32 s72, s5, 3
    s_add_u32 s53, s53, s72
    s_mul_i32 s53, s53, 196608
    s_lshr_b32 s54, s5, 2
    s_lshl_b32 s54, s54, 10
    s_add_u32 s53, s53, s54
    s_lshl_b32 s56, s3, 7
    s_add_u32 s53, s53, s56
    v_lshrrev_b32 v16, 7, v0
    v_and_b32 v17, 127, v0
    v_lshlrev_b32 v18, 10, v16
    v_lshl_add_u32 v18, v17, 1, v18
    s_lshl_b32 s55, s68, 8
    s_lshl_b32 s73, s72, 10
    v_lshlrev_b32 v30, 4, v1
    v_lshrrev_b32 v39, 1, v0
    v_and_b32 v39, 3, v39
    v_lshrrev_b32 v37, 3, v0
    v_and_b32 v36, 1, v0
    v_lshlrev_b32 v35, 10, v39
    v_lshl_add_u32 v35, v37, 3, v35
    v_lshl_add_u32 v35, v36, 2, v35
    s_waitcnt lgkmcnt(0)
    s_load_dword s7, s[42:43], 0
    s_mov_b32 s44, s34
    s_mov_b32 s45, s35
    s_mov_b32 s46, 4096
    s_mov_b32 s47, 0x00020000
    s_mov_b32 s48, s16
    s_mov_b32 s49, s17
    s_mov_b32 s50, 4096
    s_mov_b32 s51, 0x00020000
    s_mov_b32 s12, s36
    s_mov_b32 s13, s37
    s_mov_b32 s14, 3145728
    s_mov_b32 s15, 0x00020000
    buffer_load_ushort v20, v18, s[44:47], s55 offen
    buffer_load_dwordx4 v[40:43], v30, s[48:51], s73 offen
    buffer_load_dword v38, v35, s[48:51], s56 offen
    s_mov_b32 m0, s52
    s_nop 0
    buffer_load_dwordx4 v6, s[12:15], s53 offen lds
    buffer_load_dwordx4 v7, s[12:15], s53 offen offset:1024 lds
    buffer_load_dwordx4 v8, s[12:15], s53 offen offset:2048 lds
    buffer_load_dwordx4 v9, s[12:15], s53 offen offset:3072 lds
    s_mov_b32 s8, s42
    s_mov_b32 s9, s43
    s_mov_b32 s10, 7340032
    s_mov_b32 s11, 0x00020000
    s_waitcnt lgkmcnt(0)
    s_add_u32 s6, s7, 1
    s_mul_i32 s6, s6, 0x9e3779b1
    s_add_u32 s6, s6, 0x7f4a7c15
    v_lshrrev_b32 v6, 2, v3
    v_lshl_add_u32 v6, v2, 2, v6
    v_lshrrev_b32 v7, 1, v6
    v_and_b32 v7, 3, v7
    v_lshlrev_b32 v7, 5, v7
    v_lshl_add_u32 v6, v6, 7, v7
    v_lshrrev_b32 v7, 1, v4
    v_lshl_add_u32 v6, v7, 4, v6
    v_and_b32 v7, 1, v4
    v_lshl_add_u32 v6, v7, 3, v6
    v_add_u32 v6, s52, v6
    v_xor_b32 v7, 32, v6
    v_xor_b32 v8, 64, v6
    v_xor_b32 v9, 96, v6
    s_mov_b32 s96, 0xf000f0
    s_mov_b32 s97, 0xf000f0
    s_mov_b32 s98, 0xf000f00
    s_mov_b32 s99, 0xf000f00
    s_mov_b32 s100, 0xf000f000
    s_mov_b32 s101, 0xf000f000
    v_mul_u32_u24 v10, 320, v16
    v_lshrrev_b32 v11, 5, v17
    v_lshl_add_u32 v10, v11, 6, v10
    v_lshrrev_b32 v11, 2, v17
    v_and_b32 v11, 3, v11
    v_lshl_add_u32 v10, v11, 4, v10
    v_lshrrev_b32 v11, 4, v17
    v_and_b32 v11, 1, v11
    v_lshl_add_u32 v10, v11, 3, v10
    v_and_b32 v11, 3, v17
    v_lshl_add_u32 v10, v11, 1, v10
    v_add_u32 v10, 152576, v10
    v_mul_u32_u24 v11, 320, v4
    v_lshl_add_u32 v11, v2, 4, v11
    s_lshl_b32 s53, s72, 6
    s_add_u32 s53, s53, 152576
    v_add_u32 v11, s53, v11
    s_lshl_b32 s53, s5, 10
    s_add_u32 s53, s53, 131072
    v_lshrrev_b32 v12, 2, v3
    v_lshlrev_b32 v12, 8, v12
    v_lshl_add_u32 v12, v2, 6, v12
    v_lshl_add_u32 v12, v4, 4, v12
    v_add_u32 v12, s53, v12
    v_lshlrev_b32 v13, 3, v0
    v_add_u32 v13, 131072, v13
    v_lshlrev_b32 v14, 3, v39
    v_add_u32 v14, 152064, v14
    v_lshlrev_b32 v15, 11, v39
    v_lshl_add_u32 v15, v37, 4, v15
    v_lshl_add_u32 v15, v36, 3, v15
    s_lshl_b32 s74, s68, 13
    s_lshl_b32 s53, s3, 8
    s_add_u32 s74, s74, s53
    s_add_u32 s74, s74, 5242880
    s_lshl_b32 s56, s72, 3
    s_add_u32 s56, s56, 152064
    v_mov_b32 v50, s56
    s_cmp_eq_u32 s68, 0
    s_cselect_b32 s75, 1.0, 0
    v_mov_b32 v45, s6
    s_waitcnt vmcnt(6)
    v_lshlrev_b32 v20, 16, v20
    v_mul_f32 v21, 0xbfb8aa3b, v20
    v_exp_f32 v21, v21
    s_nop 0
    v_add_f32 v21, 1.0, v21
    v_rcp_f32 v21, v21
    s_nop 0
    v_mul_f32 v20, v20, v21
    v_cvt_pk_bf16_f32 v20, v20, v20
    ds_write_b16 v10, v20
    s_waitcnt vmcnt(5)
    v_lshlrev_b32 v52, 16, v40
    v_and_b32 v53, 0xffff0000, v40
    v_lshlrev_b32 v54, 16, v41
    v_and_b32 v55, 0xffff0000, v41
    v_lshlrev_b32 v56, 16, v42
    v_and_b32 v57, 0xffff0000, v42
    v_lshlrev_b32 v58, 16, v43
    v_and_b32 v59, 0xffff0000, v43
    v_add_f32 v48, v52, v53
    v_mul_f32 v49, v52, v52
    v_fmac_f32 v49, v53, v53
    v_add_f32 v48, v48, v54
    v_fmac_f32 v49, v54, v54
    v_add_f32 v48, v48, v55
    v_fmac_f32 v49, v55, v55
    v_add_f32 v48, v48, v56
    v_fmac_f32 v49, v56, v56
    v_add_f32 v48, v48, v57
    v_fmac_f32 v49, v57, v57
    v_add_f32 v48, v48, v58
    v_fmac_f32 v49, v58, v58
    v_add_f32 v48, v48, v59
    v_fmac_f32 v49, v59, v59
    s_nop 0
    v_add_f32_dpp v48, v48, v48 row_ror:8 row_mask:0xf bank_mask:0xf
    v_add_f32_dpp v49, v49, v49 row_ror:8 row_mask:0xf bank_mask:0xf
    s_nop 0
    v_add_f32_dpp v48, v48, v48 row_ror:4 row_mask:0xf bank_mask:0xf
    v_add_f32_dpp v49, v49, v49 row_ror:4 row_mask:0xf bank_mask:0xf
    s_nop 0
    v_add_f32_dpp v48, v48, v48 row_ror:2 row_mask:0xf bank_mask:0xf
    v_add_f32_dpp v49, v49, v49 row_ror:2 row_mask:0xf bank_mask:0xf
    s_nop 0
    v_add_f32_dpp v48, v48, v48 row_ror:1 row_mask:0xf bank_mask:0xf
    v_add_f32_dpp v49, v49, v49 row_ror:1 row_mask:0xf bank_mask:0xf
    v_mov_b32 v51, v48
    v_mov_b32 v52, v49
    s_nop 0
    v_permlane16_swap_b32 v48, v51
    v_permlane16_swap_b32 v49, v52
    v_add_f32 v48, v48, v51
    v_add_f32 v49, v49, v52
    v_mov_b32 v51, v48
    v_mov_b32 v52, v49
    s_nop 0
    v_permlane32_swap_b32 v48, v51
    v_permlane32_swap_b32 v49, v52
    v_add_f32 v48, v48, v51
    v_add_f32 v49, v49, v52
    v_mul_f32 v48, 0x3b000000, v48
    v_mul_f32 v49, 0x3b000000, v49
    v_fma_f32 v49, -v48, v48, v49
    v_max_f32 v49, 0, v49
    v_add_f32 v49, 0x3727c5ac, v49
    v_rsq_f32 v49, v49
    s_nop 0
    ds_write_b64 v50, v[48:49]
    s_waitcnt lgkmcnt(0)
    s_barrier
    ds_read_b128 v[52:55], v11
    s_waitcnt vmcnt(0)
    ds_read_b64_tr_b16 v[16:17], v6 offset:0
    ds_read_b64_tr_b16 v[18:19], v6 offset:2048
    ds_read_b64_tr_b16 v[20:21], v7 offset:0
    ds_read_b64_tr_b16 v[22:23], v7 offset:2048
    ds_read_b64_tr_b16 v[24:25], v8 offset:0
    ds_read_b64_tr_b16 v[26:27], v8 offset:2048
    ds_read_b64_tr_b16 v[28:29], v9 offset:0
    ds_read_b64_tr_b16 v[30:31], v9 offset:2048
    s_waitcnt lgkmcnt(0)
    v_mfma_f32_16x16x32_bf16 v[60:63], v[16:19], v[52:55], 0
    v_mfma_f32_16x16x32_bf16 v[64:67], v[20:23], v[52:55], 0
    v_mfma_f32_16x16x32_bf16 v[68:71], v[24:27], v[52:55], 0
    v_mfma_f32_16x16x32_bf16 v[72:75], v[28:31], v[52:55], 0
    s_nop 5
    v_cndmask_b32 v76, v60, v64, s[96:97]
    v_cndmask_b32 v76, v76, v68, s[98:99]
    v_cndmask_b32 v76, v76, v72, s[100:101]
    v_cndmask_b32 v77, v61, v65, s[96:97]
    v_cndmask_b32 v77, v77, v69, s[98:99]
    v_cndmask_b32 v77, v77, v73, s[100:101]
    v_cndmask_b32 v78, v62, v66, s[96:97]
    v_cndmask_b32 v78, v78, v70, s[98:99]
    v_cndmask_b32 v78, v78, v74, s[100:101]
    v_cndmask_b32 v79, v63, v67, s[96:97]
    v_cndmask_b32 v79, v79, v71, s[98:99]
    v_cndmask_b32 v79, v79, v75, s[100:101]
    ds_write_b128 v12, v[76:79]
    s_waitcnt lgkmcnt(0)
    s_barrier
    s_cmp_ge_u32 s5, 2
    s_cbranch_scc1 L_hpfin_4
    ds_read_b64 v[16:17], v13 offset:0
    ds_read_b64 v[18:19], v13 offset:1024
    ds_read_b64 v[20:21], v13 offset:2048
    ds_read_b64 v[22:23], v13 offset:3072
    ds_read_b64 v[24:25], v13 offset:4096
    ds_read_b64 v[26:27], v13 offset:5120
    ds_read_b64 v[28:29], v13 offset:6144
    ds_read_b64 v[30:31], v13 offset:7168
    ds_read_b64 v[32:33], v14
    v_lshlrev_b32 v40, 16, v38
    v_and_b32 v41, 0xffff0000, v38
    s_waitcnt lgkmcnt(0)
    v_sub_f32 v40, v40, v32
    v_sub_f32 v41, v41, v32
    v_mul_f32 v40, v40, v33
    v_mul_f32 v41, v41, v33
    v_add_f32 v16, v16, v18
    v_add_f32 v20, v20, v22
    v_add_f32 v16, v16, v20
    v_add_f32 v17, v17, v19
    v_add_f32 v21, v21, v23
    v_add_f32 v17, v17, v21
    v_add_f32 v24, v24, v26
    v_add_f32 v28, v28, v30
    v_add_f32 v24, v24, v28
    v_add_f32 v25, v25, v27
    v_add_f32 v29, v29, v31
    v_add_f32 v25, v25, v29
    v_add_f32 v24, s75, v24
    v_add_f32 v25, s75, v25
    v_fmac_f32 v16, v40, v24
    v_fmac_f32 v17, v41, v25
    v_cvt_pk_bf16_f32 v44, v16, v17
    buffer_store_dwordx2 v[44:45], v15, s[8:11], s74 offen sc1
L_hpfin_4:
    s_barrier
    s_branch L_hpdone_3
L_nohp_2:
    s_sub_u32 s53, s4, 20
    s_mul_i32 s53, s53, 6
    s_add_u32 s53, s53, s5
    s_lshl_b32 s53, s53, 3
    s_lshl_b32 s53, s53, 13
    s_lshl_b32 s54, s3, 10
    s_add_u32 s53, s53, s54
    v_lshrrev_b32 v6, 3, v1
    v_lshlrev_b32 v6, 13, v6
    v_and_b32 v7, 7, v1
    v_lshl_add_u32 v6, v7, 7, v6
    s_waitcnt lgkmcnt(0)
    s_load_dword s7, s[42:43], 0
    s_mov_b32 s44, s22
    s_mov_b32 s45, s23
    s_mov_b32 s46, 4194304
    s_mov_b32 s47, 0x00020000
    s_cmp_ge_u32 s5, 6
    s_cbranch_scc1 L_nouk_5
    buffer_load_dword v98, v6, s[44:47], s53 offen
L_nouk_5:
    s_mov_b32 s8, s42
    s_mov_b32 s9, s43
    s_mov_b32 s10, 7340032
    s_mov_b32 s11, 0x00020000
    s_waitcnt lgkmcnt(0)
    s_add_u32 s6, s7, 1
    s_mul_i32 s6, s6, 0x9e3779b1
    s_add_u32 s6, s6, 0x7f4a7c15
L_hpdone_3:
    s_sub_u32 s68, s4, 16
    s_lshr_b32 s69, s68, 2
    s_lshl_b32 s53, s3, 2
    s_add_u32 s69, s69, s53
    s_and_b32 s68, s68, 3
    s_mov_b32 s57, 0x05040100
    s_mov_b32 s58, 0x07060302
    s_mov_b32 s48, s24
    s_mov_b32 s49, s25
    s_mov_b32 s50, 4194304
    s_mov_b32 s51, 0x00020000
    v_lshrrev_b32 v97, 1, v1
    v_lshlrev_b32 v97, 13, v97
    v_and_b32 v99, 1, v1
    v_lshl_add_u32 v97, v99, 7, v97
    s_cmp_ge_u32 s5, 4
    s_cbranch_scc1 L_tuv_6
    s_lshl_b32 s53, s69, 8
    s_lshl_b32 s54, s68, 20
    s_add_u32 s53, s53, s54
    s_lshl_b32 s54, s5, 18
    s_add_u32 s53, s53, s54
    buffer_load_dword v98, v97, s[48:51], s53 offen
L_tuv_6:
    s_mov_b32 s12, s18
    s_mov_b32 s13, s19
    s_mov_b32 s14, 16777216
    s_mov_b32 s15, 0x00020000
    v_lshlrev_b32 v6, 4, v1
    v_xor_b32 v7, 32, v6
    v_xor_b32 v8, 64, v6
    v_xor_b32 v9, 96, v6
    v_xor_b32 v10, 128, v6
    v_xor_b32 v11, 160, v6
    v_xor_b32 v12, 192, v6
    v_xor_b32 v13, 224, v6
    s_add_u32 s54, s52, 0
    s_mov_b32 m0, s54
    s_add_u32 s53, s64, s54
    buffer_load_dwordx4 v6, s[12:15], s53 offen lds
    buffer_load_dwordx4 v7, s[12:15], s53 offen offset:1024 lds
    buffer_load_dwordx4 v8, s[12:15], s53 offen offset:2048 lds
    buffer_load_dwordx4 v9, s[12:15], s53 offen offset:3072 lds
    s_add_u32 s54, s52, 4096
    s_mov_b32 m0, s54
    s_add_u32 s53, s64, s54
    buffer_load_dwordx4 v10, s[12:15], s53 offen lds
    buffer_load_dwordx4 v11, s[12:15], s53 offen offset:1024 lds
    buffer_load_dwordx4 v12, s[12:15], s53 offen offset:2048 lds
    buffer_load_dwordx4 v13, s[12:15], s53 offen offset:3072 lds
    s_add_u32 s54, s52, 8192
    s_mov_b32 m0, s54
    s_add_u32 s53, s64, s54
    buffer_load_dwordx4 v6, s[12:15], s53 offen lds
    buffer_load_dwordx4 v7, s[12:15], s53 offen offset:1024 lds
    buffer_load_dwordx4 v8, s[12:15], s53 offen offset:2048 lds
    buffer_load_dwordx4 v9, s[12:15], s53 offen offset:3072 lds
    s_add_u32 s54, s52, 12288
    s_mov_b32 m0, s54
    s_add_u32 s53, s64, s54
    buffer_load_dwordx4 v10, s[12:15], s53 offen lds
    buffer_load_dwordx4 v11, s[12:15], s53 offen offset:1024 lds
    buffer_load_dwordx4 v12, s[12:15], s53 offen offset:2048 lds
    buffer_load_dwordx4 v13, s[12:15], s53 offen offset:3072 lds
    s_mov_b32 s44, s24
    s_mov_b32 s45, s25
    s_mov_b32 s46, 4194304
    s_mov_b32 s47, 0x00020000
    v_lshlrev_b32 v96, 16, v2
    v_lshl_add_u32 v96, v3, 4, v96
    s_lshl_b32 s62, s5, 19
    s_lshl_b32 s63, s69, 8
    s_add_u32 s62, s62, s63
    s_cmp_lt_u32 s4, 20
    s_cbranch_scc1 L_uvhp_8
    s_add_u32 s63, s62, 0
    buffer_load_dwordx4 v[112:115], v96, s[44:47], s63 offen
    s_add_u32 s63, s63, 8192
    buffer_load_dwordx4 v[116:119], v96, s[44:47], s63 offen
    s_add_u32 s63, s63, 8192
    buffer_load_dwordx4 v[120:123], v96, s[44:47], s63 offen
    s_add_u32 s63, s63, 8192
    buffer_load_dwordx4 v[124:127], v96, s[44:47], s63 offen
    s_add_u32 s63, s62, 32768
    buffer_load_dwordx4 v[128:131], v96, s[44:47], s63 offen
    s_add_u32 s63, s63, 8192
    buffer_load_dwordx4 v[132:135], v96, s[44:47], s63 offen
    s_add_u32 s63, s63, 8192
    buffer_load_dwordx4 v[136:139], v96, s[44:47], s63 offen
    s_add_u32 s63, s63, 8192
    buffer_load_dwordx4 v[140:143], v96, s[44:47], s63 offen
    s_branch L_uvd_7
L_uvhp_8:
L_uvd_7:
    s_branch L_att
L_qpre:
    s_lshr_b32 s69, s4, 2
    s_lshl_b32 s53, s3, 2
    s_add_u32 s69, s69, s53
    s_and_b32 s68, s4, 3
    v_lshlrev_b32 v9, 1, v2
    v_xor_b32 v10, v3, v9
    v_lshlrev_b32 v6, 13, v2
    v_lshl_add_u32 v6, v10, 4, v6
    v_xor_b32 v7, 128, v6
    v_add_u32 v8, 63488, v6
    v_add_u32 v9, 95232, v7
    v_add_u32 v7, 31744, v7
    s_lshl_b32 s62, s5, 19
    s_lshl_b32 s63, s69, 8
    s_add_u32 s62, s62, s63
    s_add_u32 s59, s68, 0
    s_and_b32 s59, s59, 3
    s_lshl_b32 s53, s59, 17
    s_add_u32 s53, s53, s62
    s_lshl_b32 s72, s59, 12
    s_add_u32 s72, s72, s52
    s_add_u32 s59, s68, 1
    s_and_b32 s59, s59, 3
    s_lshl_b32 s54, s59, 17
    s_add_u32 s54, s54, s62
    s_lshl_b32 s73, s59, 12
    s_add_u32 s73, s73, s52
    s_add_u32 s59, s68, 2
    s_and_b32 s59, s59, 3
    s_lshl_b32 s55, s59, 17
    s_add_u32 s55, s55, s62
    s_lshl_b32 s74, s59, 12
    s_add_u32 s74, s74, s52
    s_add_u32 s59, s68, 3
    s_and_b32 s59, s59, 3
    s_lshl_b32 s56, s59, 17
    s_add_u32 s56, s56, s62
    s_lshl_b32 s75, s59, 12
    s_add_u32 s75, s75, s52
    s_lshl_b32 s62, s68, 20
    s_add_u32 s62, s62, s63
    s_lshl_b32 s63, s5, 17
    s_add_u32 s62, s62, s63
    s_waitcnt lgkmcnt(0)
    s_load_dword s7, s[42:43], 0
    s_mov_b32 s12, s20
    s_mov_b32 s13, s21
    s_mov_b32 s14, 4194304
    s_mov_b32 s15, 0x00020000
    s_mov_b32 m0, s72
    s_nop 0
    buffer_load_dwordx4 v6, s[12:15], s53 offen lds
    buffer_load_dwordx4 v7, s[12:15], s53 offen offset:1024 lds
    buffer_load_dwordx4 v8, s[12:15], s53 offen offset:2048 lds
    buffer_load_dwordx4 v9, s[12:15], s53 offen offset:3072 lds
    s_mov_b32 m0, s73
    s_nop 0
    buffer_load_dwordx4 v6, s[12:15], s54 offen lds
    buffer_load_dwordx4 v7, s[12:15], s54 offen offset:1024 lds
    buffer_load_dwordx4 v8, s[12:15], s54 offen offset:2048 lds
    buffer_load_dwordx4 v9, s[12:15], s54 offen offset:3072 lds
    s_mov_b32 m0, s74
    s_nop 0
    buffer_load_dwordx4 v6, s[12:15], s55 offen lds
    buffer_load_dwordx4 v7, s[12:15], s55 offen offset:1024 lds
    buffer_load_dwordx4 v8, s[12:15], s55 offen offset:2048 lds
    buffer_load_dwordx4 v9, s[12:15], s55 offen offset:3072 lds
    s_mov_b32 m0, s75
    s_nop 0
    buffer_load_dwordx4 v6, s[12:15], s56 offen lds
    buffer_load_dwordx4 v7, s[12:15], s56 offen offset:1024 lds
    buffer_load_dwordx4 v8, s[12:15], s56 offen offset:2048 lds
    buffer_load_dwordx4 v9, s[12:15], s56 offen offset:3072 lds
    s_mov_b32 s44, s22
    s_mov_b32 s45, s23
    s_mov_b32 s46, 4194304
    s_mov_b32 s47, 0x00020000
    s_lshl_b32 s63, s5, 12
    s_add_u32 s63, s63, 131072
    s_mov_b32 m0, s63
    s_nop 0
    buffer_load_dwordx4 v6, s[44:47], s62 offen lds
    buffer_load_dwordx4 v7, s[44:47], s62 offen offset:1024 lds
    buffer_load_dwordx4 v8, s[44:47], s62 offen offset:2048 lds
    buffer_load_dwordx4 v9, s[44:47], s62 offen offset:3072 lds
    s_mov_b32 s8, s42
    s_mov_b32 s9, s43
    s_mov_b32 s10, 7340032
    s_mov_b32 s11, 0x00020000
    s_waitcnt lgkmcnt(0)
    s_add_u32 s6, s7, 1
    s_mul_i32 s6, s6, 0x9e3779b1
    s_add_u32 s6, s6, 0x7f4a7c15
    v_lshrrev_b32 v8, 2, v3
    v_lshl_add_u32 v8, v2, 2, v8
    v_and_b32 v9, 7, v8
    v_lshlrev_b32 v9, 5, v9
    v_lshl_add_u32 v8, v8, 8, v9
    v_lshrrev_b32 v9, 1, v4
    v_lshl_add_u32 v8, v9, 4, v8
    v_and_b32 v9, 1, v4
    v_lshl_add_u32 v8, v9, 3, v8
    v_add_u32 v8, s52, v8
    v_xor_b32 v9, 32, v8
    v_xor_b32 v10, 64, v8
    v_xor_b32 v11, 96, v8
    v_xor_b32 v12, 128, v8
    v_xor_b32 v13, 160, v8
    v_xor_b32 v14, 192, v8
    v_xor_b32 v15, 224, v8
    v_lshlrev_b32 v152, 11, v2
    v_lshl_add_u32 v152, v3, 4, v152
    v_mul_u32_u24 v170, 192, v2
    v_lshrrev_b32 v171, 3, v3
    v_lshl_add_u32 v170, v171, 6, v170
    v_lshl_add_u32 v170, v4, 4, v170
    v_lshrrev_b32 v171, 2, v3
    v_and_b32 v171, 1, v171
    v_lshl_add_u32 v170, v171, 3, v170
    v_add_u32 v170, s52, v170
    v_mul_u32_u24 v174, 192, v4
    v_lshl_add_u32 v174, v2, 4, v174
    v_add_u32 v174, s52, v174
    s_lshl_b32 s56, s5, 8
    s_add_u32 s56, s56, 5242880
    s_add_u32 s55, s52, 2048
    v_lshrrev_b32 v156, 2, v3
    v_lshlrev_b32 v156, 8, v156
    v_lshl_add_u32 v156, v2, 6, v156
    v_lshl_add_u32 v156, v4, 4, v156
    v_add_u32 v156, s55, v156
    v_lshlrev_b32 v157, 2, v0
    v_add_u32 v157, 2048, v157
    v_add_u32 v159, 0x10000, v157
    v_lshrrev_b32 v154, 2, v1
    v_and_b32 v154, 3, v154
    v_mul_u32_u24 v154, 320, v154
    v_lshl_add_u32 v154, v2, 3, v154
    v_lshl_add_u32 v154, v4, 1, v154
    s_lshl_b32 s55, s5, 5
    s_add_u32 s55, s55, 156928
    v_add_u32 v154, s55, v154
    v_mul_u32_u24 v155, 320, v4
    v_lshl_add_u32 v155, v2, 4, v155
    v_add_u32 v155, 156928, v155
    v_lshlrev_b32 v158, 16, v4
    v_lshl_add_u32 v158, v2, 4, v158
    s_lshl_b32 s72, s69, 11
    s_lshl_b32 s54, s68, 9
    s_add_u32 s72, s72, s54
    s_lshl_b32 s54, s5, 6
    s_add_u32 s72, s72, s54
    s_add_u32 s72, s72, 65536
    s_mov_b32 s73, 0x3e0293ee
    v_mov_b32 v149, s6
    v_mov_b32 v151, s6
    v_and_b32 v5, 7, v3
    v_lshlrev_b32 v5, 5, v5
    v_lshlrev_b32 v160, 4, v2
    v_xor_b32 v160, v160, v5
    v_lshl_add_u32 v160, v3, 8, v160
    v_add_u32 v160, s63, v160
    v_xor_b32 v161, 64, v160
    v_xor_b32 v162, 128, v160
    v_xor_b32 v163, 192, v160
    s_waitcnt vmcnt(4)
    s_add_u32 s53, s56, 8192
    s_add_u32 s54, s56, 16384
    s_add_u32 s55, s56, 24576
    buffer_load_dwordx4 v[128:131], v152, s[8:11], s56 offen sc1
    buffer_load_dwordx4 v[132:135], v152, s[8:11], s53 offen sc1
    buffer_load_dwordx4 v[136:139], v152, s[8:11], s54 offen sc1
    buffer_load_dwordx4 v[140:143], v152, s[8:11], s55 offen sc1
    ds_read_b64_tr_b16 v[16:17], v8 offset:0
    ds_read_b64_tr_b16 v[18:19], v8 offset:4096
    ds_read_b64_tr_b16 v[20:21], v9 offset:0
    ds_read_b64_tr_b16 v[22:23], v9 offset:4096
    ds_read_b64_tr_b16 v[24:25], v10 offset:0
    ds_read_b64_tr_b16 v[26:27], v10 offset:4096
    ds_read_b64_tr_b16 v[28:29], v11 offset:0
    ds_read_b64_tr_b16 v[30:31], v11 offset:4096
    ds_read_b64_tr_b16 v[32:33], v12 offset:0
    ds_read_b64_tr_b16 v[34:35], v12 offset:4096
    ds_read_b64_tr_b16 v[36:37], v13 offset:0
    ds_read_b64_tr_b16 v[38:39], v13 offset:4096
    ds_read_b64_tr_b16 v[40:41], v14 offset:0
    ds_read_b64_tr_b16 v[42:43], v14 offset:4096
    ds_read_b64_tr_b16 v[44:45], v15 offset:0
    ds_read_b64_tr_b16 v[46:47], v15 offset:4096
    ds_read_b64_tr_b16 v[48:49], v8 offset:8192
    ds_read_b64_tr_b16 v[50:51], v8 offset:12288
    ds_read_b64_tr_b16 v[52:53], v9 offset:8192
    ds_read_b64_tr_b16 v[54:55], v9 offset:12288
    ds_read_b64_tr_b16 v[56:57], v10 offset:8192
    ds_read_b64_tr_b16 v[58:59], v10 offset:12288
    ds_read_b64_tr_b16 v[60:61], v11 offset:8192
    ds_read_b64_tr_b16 v[62:63], v11 offset:12288
    ds_read_b64_tr_b16 v[64:65], v12 offset:8192
    ds_read_b64_tr_b16 v[66:67], v12 offset:12288
    ds_read_b64_tr_b16 v[68:69], v13 offset:8192
    ds_read_b64_tr_b16 v[70:71], v13 offset:12288
    ds_read_b64_tr_b16 v[72:73], v14 offset:8192
    ds_read_b64_tr_b16 v[74:75], v14 offset:12288
    ds_read_b64_tr_b16 v[76:77], v15 offset:8192
    ds_read_b64_tr_b16 v[78:79], v15 offset:12288
    s_mov_b32 s96, 0xf000f0
    s_mov_b32 s97, 0xf000f0
    s_mov_b32 s98, 0xf000f00
    s_mov_b32 s99, 0xf000f00
    s_mov_b32 s100, 0xf000f000
    s_mov_b32 s101, 0xf000f000
    s_mov_b32 s12, s18
    s_mov_b32 s13, s19
    s_mov_b32 s14, 16777216
    s_mov_b32 s15, 0x00020000
    v_lshlrev_b32 v176, 4, v1
    v_xor_b32 v177, 32, v176
    v_xor_b32 v178, 64, v176
    v_xor_b32 v179, 96, v176
    v_xor_b32 v180, 128, v176
    v_xor_b32 v181, 160, v176
    v_xor_b32 v182, 192, v176
    v_xor_b32 v183, 224, v176
    s_waitcnt vmcnt(4)
    ds_read_b128 v[112:115], v160
    ds_read_b128 v[116:119], v161
    ds_read_b128 v[120:123], v162
    ds_read_b128 v[124:127], v163
    s_mov_b32 s59, 20000
    s_branch L_hfirst_9
L_poll_10:
    buffer_load_dwordx4 v[128:131], v152, s[8:11], s56 offen sc1
    buffer_load_dwordx4 v[132:135], v152, s[8:11], s53 offen sc1
    buffer_load_dwordx4 v[136:139], v152, s[8:11], s54 offen sc1
    buffer_load_dwordx4 v[140:143], v152, s[8:11], s55 offen sc1
L_hfirst_9:
    s_waitcnt vmcnt(0)
    v_xor_b32 v153, s6, v129
    v_bitop3_b32 v153, v153, v131, s6 bitop3:0xf6
    v_bitop3_b32 v153, v153, v133, s6 bitop3:0xf6
    v_bitop3_b32 v153, v153, v135, s6 bitop3:0xf6
    v_bitop3_b32 v153, v153, v137, s6 bitop3:0xf6
    v_bitop3_b32 v153, v153, v139, s6 bitop3:0xf6
    v_bitop3_b32 v153, v153, v141, s6 bitop3:0xf6
    v_bitop3_b32 v153, v153, v143, s6 bitop3:0xf6
    v_cmp_ne_u32 vcc, 0, v153
    s_cbranch_vccz L_ok_11
    s_sub_u32 s59, s59, 1
    s_cbranch_scc1 L_fail_1
    s_sleep 1
    s_branch L_poll_10
L_ok_11:
    s_mov_b32 s53, 0x00003f80
    s_mov_b32 s54, 0x3f800000
    v_dot2_f32_bf16 v144, v128, s53, 0
    v_dot2_f32_bf16 v145, v128, s54, 0
    v_dot2_f32_bf16 v146, v130, s53, 0
    v_dot2_f32_bf16 v147, v130, s54, 0
    v_dot2_f32_bf16 v144, v132, s53, v144
    v_dot2_f32_bf16 v145, v132, s54, v145
    v_dot2_f32_bf16 v146, v134, s53, v146
    v_dot2_f32_bf16 v147, v134, s54, v147
    v_dot2_f32_bf16 v144, v136, s53, v144
    v_dot2_f32_bf16 v145, v136, s54, v145
    v_dot2_f32_bf16 v146, v138, s53, v146
    v_dot2_f32_bf16 v147, v138, s54, v147
    v_dot2_f32_bf16 v144, v140, s53, v144
    v_dot2_f32_bf16 v145, v140, s54, v145
    v_dot2_f32_bf16 v146, v142, s53, v146
    v_dot2_f32_bf16 v147, v142, s54, v147
    s_nop 0
    v_cvt_pk_bf16_f32 v144, v144, v145
    s_nop 0
    v_cvt_pk_bf16_f32 v145, v146, v147
    ds_write_b64 v170, v[144:145]
    s_waitcnt lgkmcnt(0)
    ds_read_b128 v[128:131], v174
    ds_read_b128 v[136:139], v174 offset:64
    s_add_u32 s63, s52, 4096
    s_mov_b32 m0, s63
    s_add_u32 s62, s64, s63
    buffer_load_dwordx4 v180, s[12:15], s62 offen nt lds
    buffer_load_dwordx4 v181, s[12:15], s62 offen offset:1024 nt lds
    buffer_load_dwordx4 v182, s[12:15], s62 offen offset:2048 nt lds
    buffer_load_dwordx4 v183, s[12:15], s62 offen offset:3072 nt lds
    s_waitcnt lgkmcnt(0)
    v_mfma_f32_16x16x32_bf16 v[80:83], v[16:19], v[128:131], 0
    v_mfma_f32_16x16x32_bf16 v[84:87], v[20:23], v[128:131], 0
    v_mfma_f32_16x16x32_bf16 v[88:91], v[24:27], v[128:131], 0
    v_mfma_f32_16x16x32_bf16 v[92:95], v[28:31], v[128:131], 0
    v_mfma_f32_16x16x32_bf16 v[96:99], v[32:35], v[128:131], 0
    v_mfma_f32_16x16x32_bf16 v[100:103], v[36:39], v[128:131], 0
    v_mfma_f32_16x16x32_bf16 v[104:107], v[40:43], v[128:131], 0
    v_mfma_f32_16x16x32_bf16 v[108:111], v[44:47], v[128:131], 0
    v_mfma_f32_16x16x32_bf16 v[80:83], v[48:51], v[136:139], v[80:83]
    v_mfma_f32_16x16x32_bf16 v[84:87], v[52:55], v[136:139], v[84:87]
    v_mfma_f32_16x16x32_bf16 v[88:91], v[56:59], v[136:139], v[88:91]
    v_mfma_f32_16x16x32_bf16 v[92:95], v[60:63], v[136:139], v[92:95]
    v_mfma_f32_16x16x32_bf16 v[96:99], v[64:67], v[136:139], v[96:99]
    v_mfma_f32_16x16x32_bf16 v[100:103], v[68:71], v[136:139], v[100:103]
    v_mfma_f32_16x16x32_bf16 v[104:107], v[72:75], v[136:139], v[104:107]
    v_mfma_f32_16x16x32_bf16 v[108:111], v[76:79], v[136:139], v[108:111]
    s_nop 1
    v_cndmask_b32 v136, v80, v84, s[96:97]
    v_cndmask_b32 v136, v136, v88, s[98:99]
    v_cndmask_b32 v136, v136, v92, s[100:101]
    v_cndmask_b32 v137, v81, v85, s[96:97]
    v_cndmask_b32 v137, v137, v89, s[98:99]
    v_cndmask_b32 v137, v137, v93, s[100:101]
    v_cndmask_b32 v138, v82, v86, s[96:97]
    v_cndmask_b32 v138, v138, v90, s[98:99]
    v_cndmask_b32 v138, v138, v94, s[100:101]
    v_cndmask_b32 v139, v83, v87, s[96:97]
    v_cndmask_b32 v139, v139, v91, s[98:99]
    v_cndmask_b32 v139, v139, v95, s[100:101]
    ds_write_b128 v156, v[136:139] offset:0
    v_cndmask_b32 v140, v96, v100, s[96:97]
    v_cndmask_b32 v140, v140, v104, s[98:99]
    v_cndmask_b32 v140, v140, v108, s[100:101]
    v_cndmask_b32 v141, v97, v101, s[96:97]
    v_cndmask_b32 v141, v141, v105, s[98:99]
    v_cndmask_b32 v141, v141, v109, s[100:101]
    v_cndmask_b32 v142, v98, v102, s[96:97]
    v_cndmask_b32 v142, v142, v106, s[98:99]
    v_cndmask_b32 v142, v142, v110, s[100:101]
    v_cndmask_b32 v143, v99, v103, s[96:97]
    v_cndmask_b32 v143, v143, v107, s[98:99]
    v_cndmask_b32 v143, v143, v111, s[100:101]
    ds_write_b128 v156, v[140:143] offset:1024
    s_waitcnt lgkmcnt(0)
    s_barrier
    ds_read_b32 v128, v157 offset:0
    ds_read_b32 v129, v157 offset:16384
    ds_read_b32 v130, v157 offset:32768
    ds_read_b32 v131, v157 offset:49152
    ds_read_b32 v132, v159 offset:0
    ds_read_b32 v133, v159 offset:16384
    ds_read_b32 v134, v159 offset:32768
    ds_read_b32 v135, v159 offset:49152
    s_waitcnt lgkmcnt(0)
    v_add_f32 v128, v128, v129
    v_add_f32 v130, v130, v131
    v_add_f32 v132, v132, v133
    v_add_f32 v134, v134, v135
    v_add_f32 v128, v128, v130
    v_add_f32 v132, v132, v134
    v_add_f32 v128, v128, v132
    v_cvt_pk_bf16_f32 v128, v128, v128
    ds_write_b16 v154, v128
    s_waitcnt lgkmcnt(0)
    s_barrier
    ds_read_b128 v[128:131], v155 offset:0
    ds_read_b128 v[132:135], v155 offset:64
    ds_read_b128 v[136:139], v155 offset:128
    ds_read_b128 v[140:143], v155 offset:192
    s_waitcnt lgkmcnt(3)
    v_mfma_f32_16x16x32_bf16 v[144:147], v[112:115], v[128:131], 0
    s_waitcnt lgkmcnt(2)
    v_mfma_f32_16x16x32_bf16 v[144:147], v[116:119], v[132:135], v[144:147]
    s_waitcnt lgkmcnt(1)
    v_mfma_f32_16x16x32_bf16 v[144:147], v[120:123], v[136:139], v[144:147]
    s_waitcnt lgkmcnt(0)
    v_mfma_f32_16x16x32_bf16 v[144:147], v[124:127], v[140:143], v[144:147]
    s_nop 7
    v_mul_f32 v144, s73, v144
    v_mul_f32 v145, s73, v145
    v_mul_f32 v146, s73, v146
    v_mul_f32 v147, s73, v147
    v_cvt_pk_bf16_f32 v148, v144, v145
    v_cvt_pk_bf16_f32 v150, v146, v147
    s_mov_b64 exec, s[60:61]
    buffer_store_dwordx4 v[148:151], v158, s[8:11], s72 offen sc1
    s_mov_b64 exec, -1
    s_barrier
    s_add_u32 s63, s52, 0
    s_mov_b32 m0, s63
    s_add_u32 s62, s64, s63
    buffer_load_dwordx4 v176, s[12:15], s62 offen nt lds
    buffer_load_dwordx4 v177, s[12:15], s62 offen offset:1024 nt lds
    buffer_load_dwordx4 v178, s[12:15], s62 offen offset:2048 nt lds
    buffer_load_dwordx4 v179, s[12:15], s62 offen offset:3072 nt lds
    s_add_u32 s63, s52, 12288
    s_mov_b32 m0, s63
    s_add_u32 s62, s64, s63
    buffer_load_dwordx4 v180, s[12:15], s62 offen nt lds
    buffer_load_dwordx4 v181, s[12:15], s62 offen offset:1024 nt lds
    buffer_load_dwordx4 v182, s[12:15], s62 offen offset:2048 nt lds
    buffer_load_dwordx4 v183, s[12:15], s62 offen offset:3072 nt lds
    s_add_u32 s63, s52, 8192
    s_mov_b32 m0, s63
    s_add_u32 s62, s64, s63
    buffer_load_dwordx4 v176, s[12:15], s62 offen nt lds
    buffer_load_dwordx4 v177, s[12:15], s62 offen offset:1024 nt lds
    buffer_load_dwordx4 v178, s[12:15], s62 offen offset:2048 nt lds
    buffer_load_dwordx4 v179, s[12:15], s62 offen offset:3072 nt lds
    s_mov_b32 s48, s26
    s_mov_b32 s49, s27
    s_mov_b32 s50, 4194304
    s_mov_b32 s51, 0x00020000
    v_lshlrev_b32 v97, 7, v1
    s_lshl_b32 s62, s69, 17
    s_lshl_b32 s63, s68, 15
    s_add_u32 s62, s62, s63
    s_lshl_b32 s63, s5, 13
    s_add_u32 s62, s62, s63
L_att:
    v_and_b32 v5, 7, v3
    v_lshlrev_b32 v5, 5, v5
    v_lshlrev_b32 v244, 4, v2
    v_xor_b32 v244, v244, v5
    v_lshl_add_u32 v244, v3, 10, v244
    v_xor_b32 v245, 64, v244
    v_xor_b32 v246, 128, v244
    v_xor_b32 v247, 192, v244
    v_add_u32 v248, 131072, v244
    v_add_u32 v249, 131072, v245
    v_add_u32 v250, 131072, v246
    v_add_u32 v251, 131072, v247
    v_add_u32 v244, s52, v244
    v_add_u32 v245, s52, v245
    v_add_u32 v246, s52, v246
    v_add_u32 v247, s52, v247
    v_lshrrev_b32 v80, 2, v3
    v_lshl_add_u32 v80, v2, 2, v80
    v_and_b32 v81, 7, v80
    v_lshlrev_b32 v81, 5, v81
    s_lshl_b32 s53, s5, 7
    v_lshl_add_u32 v82, v4, 4, s53
    v_xor_b32 v81, v81, v82
    v_lshl_add_u32 v80, v80, 10, v81
    v_lshrrev_b32 v81, 1, v4
    v_lshl_add_u32 v80, v81, 3, v80
    v_xor_b32 v81, 8, v80
    v_xor_b32 v82, 64, v80
    v_xor_b32 v83, 72, v80
    v_add_u32 v100, 0x10000, v80
    v_add_u32 v101, 0x10000, v81
    v_add_u32 v102, 0x10000, v82
    v_add_u32 v103, 0x10000, v83
    v_mov_b32 v240, 0x3f803f80
    v_mov_b32 v241, 0x3f803f80
    v_mov_b32 v242, 0x3f803f80
    v_mov_b32 v243, 0x3f803f80
    v_lshlrev_b32 v84, 4, v0
    v_lshrrev_b32 v85, 2, v1
    v_lshlrev_b32 v85, 11, v85
    v_lshl_add_u32 v85, v4, 9, v85
    v_add_u32 v85, 504, v85
    s_lshr_b32 s53, s5, 1
    v_and_b32 v86, 127, v0
    v_lshrrev_b32 v87, 1, v86
    s_lshl_b32 s54, s53, 1
    v_xor_b32 v87, s54, v87
    v_lshlrev_b32 v87, 4, v87
    v_and_b32 v86, 1, v86
    v_lshl_add_u32 v86, v86, 3, v87
    s_lshl_b32 s54, s53, 10
    s_add_u32 s54, s54, 131072
    v_add_u32 v86, s54, v86
    v_xor_b32 v87, 128, v86
    v_lshlrev_b32 v89, 5, v3
    s_lshl_b32 s54, s5, 2
    s_add_u32 s55, s54, 151552
    v_add_u32 v88, s55, v89
    s_add_u32 s55, s54, 152064
    v_add_u32 v91, s55, v89
    v_add_u32 v92, 152064, v89
    v_add_u32 v89, 151552, v89
    s_lshl_b32 s53, s53, 10
    s_and_b32 s54, s5, 1
    s_lshl_b32 s54, s54, 3
    s_add_u32 s53, s53, s54
    s_add_u32 s53, s53, 147456
    v_lshl_add_u32 v90, v1, 4, s53
    v_lshlrev_b32 v93, 4, v1
    v_add_u32 v93, 147456, v93
    v_lshlrev_b32 v94, 15, v3
    v_lshl_add_u32 v94, v2, 4, v94
    v_lshlrev_b32 v95, 8, v3
    s_lshl_b32 s53, s65, 5
    s_lshl_b32 s54, s67, 4
    s_add_u32 s53, s53, s54
    s_lshl_b32 s71, s53, 8
    s_lshl_b32 s54, s66, 3
    s_add_u32 s71, s71, s54
    s_add_u32 s71, s71, 5373952
    s_lshl_b32 s70, s53, 5
    s_add_u32 s70, s70, s66
    s_lshl_b32 s70, s70, 10
    s_lshl_b32 s54, s5, 7
    s_add_u32 s70, s70, s54
    s_add_u32 s70, s70, 1048576
    s_lshl_b32 s72, s65, 16
    s_lshl_b32 s54, s67, 15
    s_add_u32 s72, s72, s54
    s_add_u32 s72, s72, 65536
    s_add_u32 s73, s72, 8192
    s_add_u32 s74, s72, 16384
    s_add_u32 s75, s72, 24576
    s_cmp_lt_u32 s4, 16
    s_cbranch_scc1 L_qnotrig_13
    s_cmp_lg_u32 s5, 0
    s_cbranch_scc1 L_notrig_12
    s_mov_b32 s59, 20000
L_poll_14:
    buffer_load_dwordx2 v[176:177], v85, s[8:11], s72 offen sc1
    s_waitcnt vmcnt(0)
    v_xor_b32 v192, s6, v177
    v_cmp_ne_u32 vcc, 0, v192
    s_cbranch_vccz L_ok_15
    s_sub_u32 s59, s59, 1
    s_cbranch_scc1 L_fail_2
    s_sleep 1
    s_branch L_poll_14
L_ok_15:
L_notrig_12:
    s_barrier
L_qnotrig_13:
    s_mov_b32 s59, 20000
L_poll_16:
    buffer_load_dwordx4 v[176:179], v84, s[8:11], s72 offen sc1
    buffer_load_dwordx4 v[180:183], v84, s[8:11], s73 offen sc1
    buffer_load_dwordx4 v[184:187], v84, s[8:11], s74 offen sc1
    buffer_load_dwordx4 v[188:191], v84, s[8:11], s75 offen sc1
    s_waitcnt vmcnt(4)
    ds_read_b128 v[16:19], v244 offset:0
    ds_read_b128 v[20:23], v245 offset:0
    ds_read_b128 v[24:27], v246 offset:0
    ds_read_b128 v[28:31], v247 offset:0
    ds_read_b128 v[32:35], v244 offset:256
    ds_read_b128 v[36:39], v245 offset:256
    ds_read_b128 v[40:43], v246 offset:256
    ds_read_b128 v[44:47], v247 offset:256
    ds_read_b128 v[48:51], v244 offset:512
    ds_read_b128 v[52:55], v245 offset:512
    ds_read_b128 v[56:59], v246 offset:512
    ds_read_b128 v[60:63], v247 offset:512
    ds_read_b128 v[64:67], v244 offset:768
    ds_read_b128 v[68:71], v245 offset:768
    ds_read_b128 v[72:75], v246 offset:768
    ds_read_b128 v[76:79], v247 offset:768
    s_waitcnt vmcnt(0)
    v_xor_b32 v192, s6, v177
    v_bitop3_b32 v192, v192, v179, s6 bitop3:0xf6
    v_bitop3_b32 v192, v192, v181, s6 bitop3:0xf6
    v_bitop3_b32 v192, v192, v183, s6 bitop3:0xf6
    v_bitop3_b32 v192, v192, v185, s6 bitop3:0xf6
    v_bitop3_b32 v192, v192, v187, s6 bitop3:0xf6
    v_bitop3_b32 v192, v192, v189, s6 bitop3:0xf6
    v_bitop3_b32 v192, v192, v191, s6 bitop3:0xf6
    v_cmp_ne_u32 vcc, 0, v192
    s_cbranch_vccz L_ok_17
    s_sub_u32 s59, s59, 1
    s_cbranch_scc1 L_fail_3
    s_sleep 1
    s_branch L_poll_16
L_ok_17:
    v_mov_b32 v177, v178
    ds_write_b64 v86, v[176:177] offset:0
    v_mov_b32 v181, v182
    ds_write_b64 v87, v[180:181] offset:4096
    v_mov_b32 v185, v186
    ds_write_b64 v86, v[184:185] offset:8192
    v_mov_b32 v189, v190
    ds_write_b64 v87, v[188:189] offset:12288
    s_cmp_lt_u32 s4, 16
    s_cbranch_scc1 L_uvd_18
    s_cmp_lt_u32 s4, 20
    s_cbranch_scc1 L_uvhp_19
    s_add_u32 s63, s62, 262144
    buffer_load_dwordx4 v[144:147], v96, s[44:47], s63 offen
    s_add_u32 s63, s63, 8192
    buffer_load_dwordx4 v[148:151], v96, s[44:47], s63 offen
    s_add_u32 s63, s63, 8192
    buffer_load_dwordx4 v[152:155], v96, s[44:47], s63 offen
    s_add_u32 s63, s63, 8192
    buffer_load_dwordx4 v[156:159], v96, s[44:47], s63 offen
    s_branch L_uvd_18
L_uvhp_19:
    s_add_u32 s63, s62, 0
    buffer_load_dwordx4 v[112:115], v96, s[44:47], s63 offen
    s_add_u32 s63, s63, 8192
    buffer_load_dwordx4 v[116:119], v96, s[44:47], s63 offen
    s_add_u32 s63, s63, 8192
    buffer_load_dwordx4 v[120:123], v96, s[44:47], s63 offen
    s_add_u32 s63, s63, 8192
    buffer_load_dwordx4 v[124:127], v96, s[44:47], s63 offen
L_uvd_18:
    s_waitcnt lgkmcnt(0)
    s_barrier
    ds_read_b128 v[196:199], v248 offset:0
    ds_read_b128 v[200:203], v249 offset:0
    ds_read_b128 v[204:207], v250 offset:0
    ds_read_b128 v[208:211], v251 offset:0
    ds_read_b128 v[212:215], v248 offset:256
    ds_read_b128 v[216:219], v249 offset:256
    ds_read_b128 v[220:223], v250 offset:256
    ds_read_b128 v[224:227], v251 offset:256
    s_cmp_ge_u32 s4, 16
    s_cbranch_scc1 L_to_20
    s_cmp_ge_u32 s5, 4
    s_cbranch_scc1 L_to_20
    buffer_load_dword v98, v97, s[48:51], s62 offen
L_to_20:
    s_waitcnt lgkmcnt(7)
    v_mfma_f32_16x16x32_bf16 v[192:195], v[16:19], v[196:199], 0
    ds_read_b128 v[196:199], v248 offset:512
    s_waitcnt lgkmcnt(7)
    v_mfma_f32_16x16x32_bf16 v[192:195], v[20:23], v[200:203], v[192:195]
    ds_read_b128 v[200:203], v249 offset:512
    s_waitcnt lgkmcnt(7)
    v_mfma_f32_16x16x32_bf16 v[192:195], v[24:27], v[204:207], v[192:195]
    ds_read_b128 v[204:207], v250 offset:512
    s_waitcnt lgkmcnt(7)
    v_mfma_f32_16x16x32_bf16 v[192:195], v[28:31], v[208:211], v[192:195]
    ds_read_b128 v[208:211], v251 offset:512
    s_waitcnt lgkmcnt(7)
    v_mfma_f32_16x16x32_bf16 v[192:195], v[32:35], v[212:215], v[192:195]
    ds_read_b128 v[212:215], v248 offset:768
    s_waitcnt lgkmcnt(7)
    v_mfma_f32_16x16x32_bf16 v[192:195], v[36:39], v[216:219], v[192:195]
    ds_read_b128 v[216:219], v249 offset:768
    s_waitcnt lgkmcnt(7)
    v_mfma_f32_16x16x32_bf16 v[192:195], v[40:43], v[220:223], v[192:195]
    ds_read_b128 v[220:223], v250 offset:768
    s_waitcnt lgkmcnt(7)
    v_mfma_f32_16x16x32_bf16 v[192:195], v[44:47], v[224:227], v[192:195]
    ds_read_b128 v[224:227], v251 offset:768
    s_waitcnt lgkmcnt(7)
    v_mfma_f32_16x16x32_bf16 v[192:195], v[48:51], v[196:199], v[192:195]
    s_waitcnt lgkmcnt(6)
    v_mfma_f32_16x16x32_bf16 v[192:195], v[52:55], v[200:203], v[192:195]
    s_waitcnt lgkmcnt(5)
    v_mfma_f32_16x16x32_bf16 v[192:195], v[56:59], v[204:207], v[192:195]
    s_waitcnt lgkmcnt(4)
    v_mfma_f32_16x16x32_bf16 v[192:195], v[60:63], v[208:211], v[192:195]
    s_waitcnt lgkmcnt(3)
    v_mfma_f32_16x16x32_bf16 v[192:195], v[64:67], v[212:215], v[192:195]
    s_waitcnt lgkmcnt(2)
    v_mfma_f32_16x16x32_bf16 v[192:195], v[68:71], v[216:219], v[192:195]
    s_waitcnt lgkmcnt(1)
    v_mfma_f32_16x16x32_bf16 v[192:195], v[72:75], v[220:223], v[192:195]
    s_waitcnt lgkmcnt(0)
    v_mfma_f32_16x16x32_bf16 v[192:195], v[76:79], v[224:227], v[192:195]
    s_cmp_lt_u32 s4, 16
    s_cbranch_scc1 L_uvd_21
    s_cmp_lt_u32 s4, 20
    s_cbranch_scc1 L_uvhp_22
    s_branch L_uvd_21
L_uvhp_22:
    s_add_u32 s63, s62, 32768
    buffer_load_dwordx4 v[128:131], v96, s[44:47], s63 offen
    s_add_u32 s63, s63, 8192
    buffer_load_dwordx4 v[132:135], v96, s[44:47], s63 offen
    s_add_u32 s63, s63, 8192
    buffer_load_dwordx4 v[136:139], v96, s[44:47], s63 offen
    s_add_u32 s63, s63, 8192
    buffer_load_dwordx4 v[140:143], v96, s[44:47], s63 offen
L_uvd_21:
    v_max_f32 v228, v192, v193
    v_max3_f32 v228, v228, v194, v195
    v_mov_b32 v229, v228
    s_nop 1
    v_permlane16_swap_b32 v228, v229
    v_max_f32 v228, v228, v229
    v_mov_b32 v229, v228
    s_nop 1
    v_permlane32_swap_b32 v228, v229
    v_max_f32 v228, v228, v229
    ds_write_b32 v88, v228
    s_waitcnt lgkmcnt(0)
    s_barrier
    ds_read_b128 v[236:239], v89
    ds_read_b128 v[232:235], v89 offset:16
    s_cmp_lt_u32 s4, 16
    s_cbranch_scc1 L_uvd_23
    s_cmp_lt_u32 s4, 20
    s_cbranch_scc1 L_uvhp_24
    s_add_u32 s63, s62, 294912
    buffer_load_dwordx4 v[160:163], v96, s[44:47], s63 offen
    s_add_u32 s63, s63, 8192
    buffer_load_dwordx4 v[164:167], v96, s[44:47], s63 offen
    s_add_u32 s63, s63, 8192
    buffer_load_dwordx4 v[168:171], v96, s[44:47], s63 offen
    s_add_u32 s63, s63, 8192
    buffer_load_dwordx4 v[172:175], v96, s[44:47], s63 offen
    s_branch L_uvd_23
L_uvhp_24:
    s_add_u32 s63, s62, 262144
    buffer_load_dwordx4 v[144:147], v96, s[44:47], s63 offen
    s_add_u32 s63, s63, 8192
    buffer_load_dwordx4 v[148:151], v96, s[44:47], s63 offen
    s_add_u32 s63, s63, 8192
    buffer_load_dwordx4 v[152:155], v96, s[44:47], s63 offen
    s_add_u32 s63, s63, 8192
    buffer_load_dwordx4 v[156:159], v96, s[44:47], s63 offen
L_uvd_23:
    ds_read_b64_tr_b16 v[16:17], v80 offset:0
    ds_read_b64_tr_b16 v[18:19], v80 offset:16384
    ds_read_b64_tr_b16 v[20:21], v81 offset:0
    ds_read_b64_tr_b16 v[22:23], v81 offset:16384
    ds_read_b64_tr_b16 v[24:25], v82 offset:0
    ds_read_b64_tr_b16 v[26:27], v82 offset:16384
    ds_read_b64_tr_b16 v[28:29], v83 offset:0
    ds_read_b64_tr_b16 v[30:31], v83 offset:16384
    s_waitcnt lgkmcnt(8)
    v_max3_f32 v236, v236, v237, v238
    v_max3_f32 v232, v232, v233, v234
    v_max3_f32 v228, v236, v239, v232
    v_max_f32 v228, v228, v235
    v_sub_f32 v192, v192, v228
    v_sub_f32 v193, v193, v228
    v_sub_f32 v194, v194, v228
    v_sub_f32 v195, v195, v228
    v_exp_f32 v192, v192
    v_exp_f32 v193, v193
    v_exp_f32 v194, v194
    v_exp_f32 v195, v195
    s_nop 0
    v_cvt_pk_bf16_f32 v234, v192, v193
    v_cvt_pk_bf16_f32 v235, v194, v195
    ds_write_b64 v90, v[234:235]
    ds_read_b64_tr_b16 v[32:33], v80 offset:32768
    ds_read_b64_tr_b16 v[34:35], v80 offset:49152
    ds_read_b64_tr_b16 v[36:37], v81 offset:32768
    ds_read_b64_tr_b16 v[38:39], v81 offset:49152
    ds_read_b64_tr_b16 v[40:41], v82 offset:32768
    ds_read_b64_tr_b16 v[42:43], v82 offset:49152
    ds_read_b64_tr_b16 v[44:45], v83 offset:32768
    ds_read_b64_tr_b16 v[46:47], v83 offset:49152
    ds_read_b64_tr_b16 v[48:49], v100 offset:0
    ds_read_b64_tr_b16 v[50:51], v100 offset:16384
    ds_read_b64_tr_b16 v[52:53], v101 offset:0
    ds_read_b64_tr_b16 v[54:55], v101 offset:16384
    ds_read_b64_tr_b16 v[56:57], v102 offset:0
    ds_read_b64_tr_b16 v[58:59], v102 offset:16384
    ds_read_b64_tr_b16 v[60:61], v103 offset:0
    ds_read_b64_tr_b16 v[62:63], v103 offset:16384
    ds_read_b64_tr_b16 v[64:65], v100 offset:32768
    ds_read_b64_tr_b16 v[66:67], v100 offset:49152
    ds_read_b64_tr_b16 v[68:69], v101 offset:32768
    ds_read_b64_tr_b16 v[70:71], v101 offset:49152
    ds_read_b64_tr_b16 v[72:73], v102 offset:32768
    ds_read_b64_tr_b16 v[74:75], v102 offset:49152
    ds_read_b64_tr_b16 v[76:77], v103 offset:32768
    ds_read_b64_tr_b16 v[78:79], v103 offset:49152
    s_cmp_lt_u32 s4, 16
    s_cbranch_scc1 L_uvd_25
    s_cmp_lt_u32 s4, 20
    s_cbranch_scc1 L_uvhp_26
    s_branch L_uvd_25
L_uvhp_26:
    s_add_u32 s63, s62, 294912
    buffer_load_dwordx4 v[160:163], v96, s[44:47], s63 offen
    s_add_u32 s63, s63, 8192
    buffer_load_dwordx4 v[164:167], v96, s[44:47], s63 offen
    s_add_u32 s63, s63, 8192
    buffer_load_dwordx4 v[168:171], v96, s[44:47], s63 offen
    s_add_u32 s63, s63, 8192
    buffer_load_dwordx4 v[172:175], v96, s[44:47], s63 offen
L_uvd_25:
    s_waitcnt lgkmcnt(0)
    s_barrier
    ds_read_b128 v[196:199], v93 offset:0
    ds_read_b128 v[200:203], v93 offset:1024
    ds_read_b128 v[204:207], v93 offset:2048
    ds_read_b128 v[208:211], v93 offset:3072
    s_waitcnt lgkmcnt(3)
    v_mfma_f32_16x16x32_bf16 v[236:239], v[240:243], v[196:199], 0
    v_mfma_f32_16x16x32_bf16 v[212:215], v[16:19], v[196:199], 0
    v_mfma_f32_16x16x32_bf16 v[216:219], v[20:23], v[196:199], 0
    v_mfma_f32_16x16x32_bf16 v[220:223], v[24:27], v[196:199], 0
    v_mfma_f32_16x16x32_bf16 v[224:227], v[28:31], v[196:199], 0
    s_waitcnt lgkmcnt(2)
    v_mfma_f32_16x16x32_bf16 v[236:239], v[240:243], v[200:203], v[236:239]
    v_mfma_f32_16x16x32_bf16 v[212:215], v[32:35], v[200:203], v[212:215]
    v_mfma_f32_16x16x32_bf16 v[216:219], v[36:39], v[200:203], v[216:219]
    v_mfma_f32_16x16x32_bf16 v[220:223], v[40:43], v[200:203], v[220:223]
    v_mfma_f32_16x16x32_bf16 v[224:227], v[44:47], v[200:203], v[224:227]
    s_waitcnt lgkmcnt(1)
    v_mfma_f32_16x16x32_bf16 v[236:239], v[240:243], v[204:207], v[236:239]
    v_mfma_f32_16x16x32_bf16 v[212:215], v[48:51], v[204:207], v[212:215]
    v_mfma_f32_16x16x32_bf16 v[216:219], v[52:55], v[204:207], v[216:219]
    v_mfma_f32_16x16x32_bf16 v[220:223], v[56:59], v[204:207], v[220:223]
    v_mfma_f32_16x16x32_bf16 v[224:227], v[60:63], v[204:207], v[224:227]
    s_waitcnt lgkmcnt(0)
    v_mfma_f32_16x16x32_bf16 v[236:239], v[240:243], v[208:211], v[236:239]
    v_mfma_f32_16x16x32_bf16 v[212:215], v[64:67], v[208:211], v[212:215]
    v_mfma_f32_16x16x32_bf16 v[216:219], v[68:71], v[208:211], v[216:219]
    v_mfma_f32_16x16x32_bf16 v[220:223], v[72:75], v[208:211], v[220:223]
    v_mfma_f32_16x16x32_bf16 v[224:227], v[76:79], v[208:211], v[224:227]
    s_nop 3
    v_rcp_f32 v232, v236
    v_log_f32 v238, v236
    v_mov_b32 v239, s6
    v_add_f32 v238, v228, v238
    v_mul_f32 v212, v232, v212
    v_mul_f32 v213, v232, v213
    v_mul_f32 v214, v232, v214
    v_mul_f32 v215, v232, v215
    v_mul_f32 v216, v232, v216
    v_mul_f32 v217, v232, v217
    v_mul_f32 v218, v232, v218
    v_mul_f32 v219, v232, v219
    v_cvt_pk_bf16_f32 v196, v212, v213
    v_cvt_pk_bf16_f32 v197, v214, v215
    v_cvt_pk_bf16_f32 v198, v216, v217
    v_cvt_pk_bf16_f32 v199, v218, v219
    buffer_store_dwordx4 v[196:199], v94, s[8:11], s70 offen sc1
    v_mul_f32 v220, v232, v220
    v_mul_f32 v221, v232, v221
    v_mul_f32 v222, v232, v222
    v_mul_f32 v223, v232, v223
    v_mul_f32 v224, v232, v224
    v_mul_f32 v225, v232, v225
    v_mul_f32 v226, v232, v226
    v_mul_f32 v227, v232, v227
    v_cvt_pk_bf16_f32 v200, v220, v221
    v_cvt_pk_bf16_f32 v201, v222, v223
    v_cvt_pk_bf16_f32 v202, v224, v225
    v_cvt_pk_bf16_f32 v203, v226, v227
    buffer_store_dwordx4 v[200:203], v94, s[8:11], s70 offen offset:64 sc1
    s_cmp_lt_u32 s4, 16
    s_cbranch_scc1 L_qpost
    s_barrier
    s_mov_b32 s12, s26
    s_mov_b32 s13, s27
    s_mov_b32 s14, 4194304
    s_mov_b32 s15, 0x00020000
    v_lshrrev_b32 v6, 3, v1
    v_mul_u32_u24 v6, 1024, v6
    v_and_b32 v7, 7, v1
    v_lshlrev_b32 v8, 1, v2
    v_xor_b32 v7, v7, v8
    v_lshl_add_u32 v6, v7, 4, v6
    v_add_u32 v7, 7168, v6
    v_add_u32 v8, 14336, v6
    v_add_u32 v9, 21504, v6
    s_lshl_b32 s98, s69, 17
    s_lshl_b32 s99, s5, 7
    s_add_u32 s98, s98, s99
    s_add_u32 s59, s68, 0
    s_and_b32 s59, s59, 3
    s_lshl_b32 s53, s59, 15
    s_add_u32 s53, s53, s98
    s_lshl_b32 s72, s59, 12
    s_add_u32 s72, s72, s52
    s_add_u32 s59, s68, 1
    s_and_b32 s59, s59, 3
    s_lshl_b32 s54, s59, 15
    s_add_u32 s54, s54, s98
    s_lshl_b32 s73, s59, 12
    s_add_u32 s73, s73, s52
    s_add_u32 s59, s68, 2
    s_and_b32 s59, s59, 3
    s_lshl_b32 s55, s59, 15
    s_add_u32 s55, s55, s98
    s_lshl_b32 s74, s59, 12
    s_add_u32 s74, s74, s52
    s_add_u32 s59, s68, 3
    s_and_b32 s59, s59, 3
    s_lshl_b32 s56, s59, 15
    s_add_u32 s56, s56, s98
    s_lshl_b32 s75, s59, 12
    s_add_u32 s75, s75, s52
    s_mov_b32 m0, s72
    s_nop 0
    buffer_load_dwordx4 v6, s[12:15], s53 offen lds
    buffer_load_dwordx4 v7, s[12:15], s53 offen offset:1024 lds
    buffer_load_dwordx4 v8, s[12:15], s53 offen offset:2048 lds
    buffer_load_dwordx4 v9, s[12:15], s53 offen offset:3072 lds
    s_mov_b32 m0, s73
    s_nop 0
    buffer_load_dwordx4 v6, s[12:15], s54 offen lds
    buffer_load_dwordx4 v7, s[12:15], s54 offen offset:1024 lds
    buffer_load_dwordx4 v8, s[12:15], s54 offen offset:2048 lds
    buffer_load_dwordx4 v9, s[12:15], s54 offen offset:3072 lds
    s_waitcnt vmcnt(8)
    s_barrier
    s_cmp_lg_u32 s5, 0
    s_cbranch_scc1 L_nofl_27
    s_mov_b64 exec, 0xffff
    buffer_store_dwordx2 v[238:239], v95, s[8:11], s71 offen sc1
    s_mov_b64 exec, -1
L_nofl_27:
    s_mov_b32 m0, s74
    s_nop 0
    buffer_load_dwordx4 v6, s[12:15], s55 offen lds
    buffer_load_dwordx4 v7, s[12:15], s55 offen offset:1024 lds
    buffer_load_dwordx4 v8, s[12:15], s55 offen offset:2048 lds
    buffer_load_dwordx4 v9, s[12:15], s55 offen offset:3072 lds
    s_mov_b32 m0, s75
    s_nop 0
    buffer_load_dwordx4 v6, s[12:15], s56 offen lds
    buffer_load_dwordx4 v7, s[12:15], s56 offen offset:1024 lds
    buffer_load_dwordx4 v8, s[12:15], s56 offen offset:2048 lds
    buffer_load_dwordx4 v9, s[12:15], s56 offen offset:3072 lds
    v_lshrrev_b32 v220, 2, v3
    v_lshl_add_u32 v220, v2, 2, v220
    v_lshrrev_b32 v221, 1, v220
    v_and_b32 v221, 3, v221
    v_lshlrev_b32 v221, 5, v221
    v_lshl_add_u32 v220, v220, 7, v221
    v_lshrrev_b32 v221, 1, v4
    v_lshl_add_u32 v220, v221, 4, v220
    v_and_b32 v221, 1, v4
    v_lshl_add_u32 v220, v221, 3, v220
    v_add_u32 v220, s52, v220
    v_xor_b32 v221, 32, v220
    v_xor_b32 v222, 64, v220
    v_xor_b32 v223, 96, v220
    s_lshl_b32 s53, s68, 5
    s_add_u32 s53, s53, s69
    s_lshl_b32 s54, s53, 8
    s_add_u32 s54, s54, 5373952
    s_lshl_b32 s55, s53, 15
    s_lshl_b32 s56, s5, 12
    s_add_u32 s55, s55, s56
    s_add_u32 s55, s55, 1048576
    s_lshl_b32 s70, s53, 11
    s_lshl_b32 s73, s5, 8
    s_add_u32 s70, s70, s73
    s_add_u32 s70, s70, 393216
    v_and_b32 v5, 31, v1
    v_lshlrev_b32 v5, 3, v5
    v_lshlrev_b32 v6, 4, v1
    s_lshl_b32 s53, s5, 11
    s_add_u32 s53, s53, 131072
    v_lshrrev_b32 v7, 1, v1
    v_and_b32 v7, 1, v7
    v_lshlrev_b32 v7, 4, v7
    v_lshl_add_u32 v7, v1, 5, v7
    v_add_u32 v7, s53, v7
    v_xor_b32 v8, 16, v7
    s_lshl_b32 s53, s5, 3
    s_add_u32 s53, s53, 151552
    v_mov_b32 v9, s53
    v_lshlrev_b32 v10, 2, v0
    v_add_u32 v10, 131072, v10
    v_and_b32 v11, 7, v1
    v_lshlrev_b32 v11, 3, v11
    v_add_u32 v11, 151552, v11
    v_lshlrev_b32 v12, 1, v0
    v_add_u32 v12, 158208, v12
    s_lshl_b32 s53, s5, 7
    s_add_u32 s53, s53, 158208
    v_lshl_add_u32 v13, v2, 4, s53
    s_lshl_b32 s53, s5, 9
    s_add_u32 s53, s53, 159232
    v_lshlrev_b32 v14, 5, v3
    v_lshl_add_u32 v14, v2, 3, v14
    v_add_u32 v14, s53, v14
    v_lshlrev_b32 v15, 3, v1
    v_add_u32 v15, 159232, v15
    v_lshlrev_b32 v232, 6, v2
    v_lshrrev_b32 v233, 1, v1
    v_and_b32 v233, 3, v233
    v_lshl_add_u32 v232, v233, 4, v232
    v_lshrrev_b32 v233, 3, v1
    v_and_b32 v233, 1, v233
    v_lshl_add_u32 v232, v233, 3, v232
    v_and_b32 v233, 1, v1
    v_lshl_add_u32 v232, v233, 2, v232
    s_lshl_b32 s53, s5, 8
    s_add_u32 s53, s53, 147456
    v_add_u32 v232, s53, v232
    v_lshl_add_u32 v233, v2, 4, s53
    v_lshlrev_b32 v234, 6, v3
    v_lshl_add_u32 v234, v2, 4, v234
    v_mov_b32 v229, s6
    v_mov_b32 v231, s6
    s_mov_b32 s96, 0xffff0000
    s_mov_b32 s97, 0x0
    s_mov_b32 s98, 0x0
    s_mov_b32 s99, 0xffff
    s_mov_b32 s100, 0x0
    s_mov_b32 s101, 0xffff0000
    s_waitcnt vmcnt(8)
    v_perm_b32 v80, v116, v112, s57
    v_perm_b32 v84, v116, v112, s58
    v_perm_b32 v88, v117, v113, s57
    v_perm_b32 v92, v117, v113, s58
    v_perm_b32 v96, v118, v114, s57
    v_perm_b32 v100, v118, v114, s58
    v_perm_b32 v104, v119, v115, s57
    v_perm_b32 v108, v119, v115, s58
    v_perm_b32 v81, v124, v120, s57
    v_perm_b32 v85, v124, v120, s58
    v_perm_b32 v89, v125, v121, s57
    v_perm_b32 v93, v125, v121, s58
    v_perm_b32 v97, v126, v122, s57
    v_perm_b32 v101, v126, v122, s58
    v_perm_b32 v105, v127, v123, s57
    v_perm_b32 v109, v127, v123, s58
    v_perm_b32 v82, v132, v128, s57
    v_perm_b32 v86, v132, v128, s58
    v_perm_b32 v90, v133, v129, s57
    v_perm_b32 v94, v133, v129, s58
    v_perm_b32 v98, v134, v130, s57
    v_perm_b32 v102, v134, v130, s58
    v_perm_b32 v106, v135, v131, s57
    v_perm_b32 v110, v135, v131, s58
    v_perm_b32 v83, v140, v136, s57
    v_perm_b32 v87, v140, v136, s58
    v_perm_b32 v91, v141, v137, s57
    v_perm_b32 v95, v141, v137, s58
    v_perm_b32 v99, v142, v138, s57
    v_perm_b32 v103, v142, v138, s58
    v_perm_b32 v107, v143, v139, s57
    v_perm_b32 v111, v143, v139, s58
    v_perm_b32 v112, v148, v144, s57
    v_perm_b32 v116, v148, v144, s58
    v_perm_b32 v120, v149, v145, s57
    v_perm_b32 v124, v149, v145, s58
    v_perm_b32 v128, v150, v146, s57
    v_perm_b32 v132, v150, v146, s58
    v_perm_b32 v136, v151, v147, s57
    v_perm_b32 v140, v151, v147, s58
    v_perm_b32 v113, v156, v152, s57
    v_perm_b32 v117, v156, v152, s58
    v_perm_b32 v121, v157, v153, s57
    v_perm_b32 v125, v157, v153, s58
    v_perm_b32 v129, v158, v154, s57
    v_perm_b32 v133, v158, v154, s58
    v_perm_b32 v137, v159, v155, s57
    v_perm_b32 v141, v159, v155, s58
    v_perm_b32 v114, v164, v160, s57
    v_perm_b32 v118, v164, v160, s58
    v_perm_b32 v122, v165, v161, s57
    v_perm_b32 v126, v165, v161, s58
    v_perm_b32 v130, v166, v162, s57
    v_perm_b32 v134, v166, v162, s58
    v_perm_b32 v138, v167, v163, s57
    v_perm_b32 v142, v167, v163, s58
    v_perm_b32 v115, v172, v168, s57
    v_perm_b32 v119, v172, v168, s58
    v_perm_b32 v123, v173, v169, s57
    v_perm_b32 v127, v173, v169, s58
    v_perm_b32 v131, v174, v170, s57
    v_perm_b32 v135, v174, v170, s58
    v_perm_b32 v139, v175, v171, s57
    v_perm_b32 v143, v175, v171, s58
    v_and_b32 v5, 7, v3
    v_lshl_add_u32 v5, v5, 2, v2
    v_lshlrev_b32 v5, 3, v5
    v_lshlrev_b32 v6, 3, v3
    v_lshl_add_u32 v6, v2, 10, v6
    s_lshl_b32 s53, s68, 5
    s_add_u32 s53, s53, s69
    s_lshl_b32 s55, s53, 15
    s_lshl_b32 s56, s5, 7
    s_add_u32 s55, s55, s56
    s_add_u32 s55, s55, 1048576
    v_lshrrev_b32 v12, 2, v3
    v_xor_b32 v12, v12, v3
    v_and_b32 v12, 1, v12
    v_lshlrev_b32 v12, 3, v12
    v_lshrrev_b32 v7, 1, v3
    v_lshl_add_u32 v12, v7, 4, v12
    s_add_u32 s56, s56, 158208
    v_add_u32 v12, s56, v12
    s_mov_b32 s59, 20000
L_poll_28:
    buffer_load_dwordx2 v[176:177], v5, s[8:11], s54 offen sc1
    s_waitcnt vmcnt(0)
    v_xor_b32 v178, s6, v177
    v_cmp_ne_u32 vcc, 0, v178
    s_cbranch_vccz L_ok_29
    s_sub_u32 s59, s59, 1
    s_cbranch_scc1 L_fail_4
    s_sleep 1
    s_branch L_poll_28
L_ok_29:
    buffer_load_dwordx2 v[180:181], v6, s[8:11], s55 offen sc1
    s_add_u32 s55, s55, 4096
    buffer_load_dwordx2 v[182:183], v6, s[8:11], s55 offen sc1
    s_add_u32 s55, s55, 4096
    buffer_load_dwordx2 v[184:185], v6, s[8:11], s55 offen sc1
    s_add_u32 s55, s55, 4096
    buffer_load_dwordx2 v[186:187], v6, s[8:11], s55 offen sc1
    s_add_u32 s55, s55, 4096
    buffer_load_dwordx2 v[188:189], v6, s[8:11], s55 offen sc1
    s_add_u32 s55, s55, 4096
    buffer_load_dwordx2 v[190:191], v6, s[8:11], s55 offen sc1
    s_add_u32 s55, s55, 4096
    buffer_load_dwordx2 v[192:193], v6, s[8:11], s55 offen sc1
    s_add_u32 s55, s55, 4096
    buffer_load_dwordx2 v[194:195], v6, s[8:11], s55 offen sc1
    ds_read_b64_tr_b16 v[16:17], v220 offset:0
    ds_read_b64_tr_b16 v[18:19], v220 offset:2048
    ds_read_b64_tr_b16 v[20:21], v221 offset:0
    ds_read_b64_tr_b16 v[22:23], v221 offset:2048
    ds_read_b64_tr_b16 v[24:25], v222 offset:0
    ds_read_b64_tr_b16 v[26:27], v222 offset:2048
    ds_read_b64_tr_b16 v[28:29], v223 offset:0
    ds_read_b64_tr_b16 v[30:31], v223 offset:2048
    ds_read_b64_tr_b16 v[32:33], v220 offset:4096
    ds_read_b64_tr_b16 v[34:35], v220 offset:6144
    ds_read_b64_tr_b16 v[36:37], v221 offset:4096
    ds_read_b64_tr_b16 v[38:39], v221 offset:6144
    ds_read_b64_tr_b16 v[40:41], v222 offset:4096
    ds_read_b64_tr_b16 v[42:43], v222 offset:6144
    ds_read_b64_tr_b16 v[44:45], v223 offset:4096
    ds_read_b64_tr_b16 v[46:47], v223 offset:6144
    ds_read_b64_tr_b16 v[48:49], v220 offset:8192
    ds_read_b64_tr_b16 v[50:51], v220 offset:10240
    ds_read_b64_tr_b16 v[52:53], v221 offset:8192
    ds_read_b64_tr_b16 v[54:55], v221 offset:10240
    ds_read_b64_tr_b16 v[56:57], v222 offset:8192
    ds_read_b64_tr_b16 v[58:59], v222 offset:10240
    ds_read_b64_tr_b16 v[60:61], v223 offset:8192
    ds_read_b64_tr_b16 v[62:63], v223 offset:10240
    ds_read_b64_tr_b16 v[64:65], v220 offset:12288
    ds_read_b64_tr_b16 v[66:67], v220 offset:14336
    ds_read_b64_tr_b16 v[68:69], v221 offset:12288
    ds_read_b64_tr_b16 v[70:71], v221 offset:14336
    ds_read_b64_tr_b16 v[72:73], v222 offset:12288
    ds_read_b64_tr_b16 v[74:75], v222 offset:14336
    ds_read_b64_tr_b16 v[76:77], v223 offset:12288
    ds_read_b64_tr_b16 v[78:79], v223 offset:14336
    v_mov_b32 v178, v176
    s_nop 1
    v_max_f32_dpp v178, v178, v178 quad_perm:[1,0,3,2] row_mask:0xf bank_mask:0xf
    s_nop 1
    v_max_f32_dpp v178, v178, v178 quad_perm:[2,3,0,1] row_mask:0xf bank_mask:0xf
    s_nop 1
    v_max_f32_dpp v178, v178, v178 row_half_mirror row_mask:0xf bank_mask:0xf
    v_mov_b32 v179, v178
    s_nop 1
    v_permlane16_swap_b32 v178, v179
    v_max_f32 v178, v178, v179
    v_mov_b32 v179, v178
    s_nop 1
    v_permlane32_swap_b32 v178, v179
    v_max_f32 v178, v178, v179
    v_sub_f32 v176, v176, v178
    v_exp_f32 v176, v176
    s_nop 0
    v_cvt_pk_bf16_f32 v177, v176, v176
    v_and_b32 v176, 0xffff0000, v177
    v_and_b32 v177, 0xffff, v177
    v_mov_b32 v178, v176
    s_nop 1
    v_add_f32_dpp v178, v178, v178 quad_perm:[1,0,3,2] row_mask:0xf bank_mask:0xf
    s_nop 1
    v_add_f32_dpp v178, v178, v178 quad_perm:[2,3,0,1] row_mask:0xf bank_mask:0xf
    s_nop 1
    v_add_f32_dpp v178, v178, v178 row_half_mirror row_mask:0xf bank_mask:0xf
    v_mov_b32 v179, v178
    s_nop 1
    v_permlane16_swap_b32 v178, v179
    v_add_f32 v178, v178, v179
    v_mov_b32 v179, v178
    s_nop 1
    v_permlane32_swap_b32 v178, v179
    v_add_f32 v178, v178, v179
    v_rcp_f32 v203, v178
    v_mov_b32_dpp v212, v177 row_newbcast:0 row_mask:0xf bank_mask:0xf
    v_mov_b32_dpp v213, v176 row_newbcast:0 row_mask:0xf bank_mask:0xf
    v_mov_b32_dpp v214, v177 row_newbcast:1 row_mask:0xf bank_mask:0xf
    v_mov_b32_dpp v215, v176 row_newbcast:1 row_mask:0xf bank_mask:0xf
    v_mov_b32_dpp v216, v177 row_newbcast:2 row_mask:0xf bank_mask:0xf
    v_mov_b32_dpp v217, v176 row_newbcast:2 row_mask:0xf bank_mask:0xf
    v_mov_b32_dpp v218, v177 row_newbcast:3 row_mask:0xf bank_mask:0xf
    v_mov_b32_dpp v219, v176 row_newbcast:3 row_mask:0xf bank_mask:0xf
    v_mov_b32_dpp v220, v177 row_newbcast:4 row_mask:0xf bank_mask:0xf
    v_mov_b32_dpp v221, v176 row_newbcast:4 row_mask:0xf bank_mask:0xf
    v_mov_b32_dpp v222, v177 row_newbcast:5 row_mask:0xf bank_mask:0xf
    v_mov_b32_dpp v223, v176 row_newbcast:5 row_mask:0xf bank_mask:0xf
    v_mov_b32_dpp v224, v177 row_newbcast:6 row_mask:0xf bank_mask:0xf
    v_mov_b32_dpp v225, v176 row_newbcast:6 row_mask:0xf bank_mask:0xf
    v_mov_b32_dpp v226, v177 row_newbcast:7 row_mask:0xf bank_mask:0xf
    v_mov_b32_dpp v227, v176 row_newbcast:7 row_mask:0xf bank_mask:0xf
    s_waitcnt vmcnt(7)
    v_dot2_f32_bf16 v204, v180, v212, 0
    v_dot2_f32_bf16 v205, v180, v213, 0
    v_dot2_f32_bf16 v206, v181, v212, 0
    v_dot2_f32_bf16 v207, v181, v213, 0
    s_waitcnt vmcnt(6)
    v_dot2_f32_bf16 v204, v182, v214, v204
    v_dot2_f32_bf16 v205, v182, v215, v205
    v_dot2_f32_bf16 v206, v183, v214, v206
    v_dot2_f32_bf16 v207, v183, v215, v207
    s_waitcnt vmcnt(5)
    v_dot2_f32_bf16 v204, v184, v216, v204
    v_dot2_f32_bf16 v205, v184, v217, v205
    v_dot2_f32_bf16 v206, v185, v216, v206
    v_dot2_f32_bf16 v207, v185, v217, v207
    s_waitcnt vmcnt(4)
    v_dot2_f32_bf16 v204, v186, v218, v204
    v_dot2_f32_bf16 v205, v186, v219, v205
    v_dot2_f32_bf16 v206, v187, v218, v206
    v_dot2_f32_bf16 v207, v187, v219, v207
    s_waitcnt vmcnt(3)
    v_dot2_f32_bf16 v204, v188, v220, v204
    v_dot2_f32_bf16 v205, v188, v221, v205
    v_dot2_f32_bf16 v206, v189, v220, v206
    v_dot2_f32_bf16 v207, v189, v221, v207
    s_waitcnt vmcnt(2)
    v_dot2_f32_bf16 v204, v190, v222, v204
    v_dot2_f32_bf16 v205, v190, v223, v205
    v_dot2_f32_bf16 v206, v191, v222, v206
    v_dot2_f32_bf16 v207, v191, v223, v207
    s_waitcnt vmcnt(1)
    v_dot2_f32_bf16 v204, v192, v224, v204
    v_dot2_f32_bf16 v205, v192, v225, v205
    v_dot2_f32_bf16 v206, v193, v224, v206
    v_dot2_f32_bf16 v207, v193, v225, v207
    s_waitcnt vmcnt(0)
    v_dot2_f32_bf16 v204, v194, v226, v204
    v_dot2_f32_bf16 v205, v194, v227, v205
    v_dot2_f32_bf16 v206, v195, v226, v206
    v_dot2_f32_bf16 v207, v195, v227, v207
    v_mov_b32 v208, v204
    v_mov_b32 v209, v205
    v_mov_b32 v210, v206
    v_mov_b32 v211, v207
    v_permlane16_swap_b32 v204, v208
    v_permlane16_swap_b32 v205, v209
    v_permlane16_swap_b32 v206, v210
    v_permlane16_swap_b32 v207, v211
    v_add_f32 v204, v204, v208
    v_add_f32 v205, v205, v209
    v_add_f32 v206, v206, v210
    v_add_f32 v207, v207, v211
    v_mov_b32 v208, v204
    v_mov_b32 v209, v205
    v_mov_b32 v210, v206
    v_mov_b32 v211, v207
    v_permlane32_swap_b32 v204, v208
    v_permlane32_swap_b32 v205, v209
    v_permlane32_swap_b32 v206, v210
    v_permlane32_swap_b32 v207, v211
    v_add_f32 v204, v204, v208
    v_add_f32 v205, v205, v209
    v_add_f32 v206, v206, v210
    v_add_f32 v207, v207, v211
    v_mul_f32 v204, v204, v203
    v_mul_f32 v205, v205, v203
    v_mul_f32 v206, v206, v203
    v_mul_f32 v207, v207, v203
    v_cvt_pk_bf16_f32 v204, v204, v205
    v_cvt_pk_bf16_f32 v205, v206, v207
    ds_write_b64 v12, v[204:205]
    s_waitcnt lgkmcnt(0)
    ds_read_b128 v[176:179], v13
    ds_read_b128 v[180:183], v13 offset:64
    s_waitcnt lgkmcnt(1)
    v_mfma_f32_16x16x32_bf16 v[184:187], v[176:179], v[80:83], 0
    v_mfma_f32_16x16x32_bf16 v[188:191], v[176:179], v[84:87], 0
    v_mfma_f32_16x16x32_bf16 v[192:195], v[176:179], v[88:91], 0
    v_mfma_f32_16x16x32_bf16 v[196:199], v[176:179], v[92:95], 0
    v_mfma_f32_16x16x32_bf16 v[200:203], v[176:179], v[96:99], 0
    v_mfma_f32_16x16x32_bf16 v[204:207], v[176:179], v[100:103], 0
    v_mfma_f32_16x16x32_bf16 v[208:211], v[176:179], v[104:107], 0
    v_mfma_f32_16x16x32_bf16 v[212:215], v[176:179], v[108:111], 0
    s_waitcnt lgkmcnt(0)
    v_mfma_f32_16x16x32_bf16 v[184:187], v[180:183], v[112:115], v[184:187]
    v_mfma_f32_16x16x32_bf16 v[188:191], v[180:183], v[116:119], v[188:191]
    v_mfma_f32_16x16x32_bf16 v[192:195], v[180:183], v[120:123], v[192:195]
    v_mfma_f32_16x16x32_bf16 v[196:199], v[180:183], v[124:127], v[196:199]
    v_mfma_f32_16x16x32_bf16 v[200:203], v[180:183], v[128:131], v[200:203]
    v_mfma_f32_16x16x32_bf16 v[204:207], v[180:183], v[132:135], v[204:207]
    v_mfma_f32_16x16x32_bf16 v[208:211], v[180:183], v[136:139], v[208:211]
    v_mfma_f32_16x16x32_bf16 v[212:215], v[180:183], v[140:143], v[212:215]
    s_nop 2
    v_cndmask_b32 v216, v184, v192, s[96:97]
    s_nop 0
    v_cndmask_b32 v216, v216, v200, s[98:99]
    s_nop 0
    v_cndmask_b32 v216, v216, v208, s[100:101]
    v_cndmask_b32 v217, v188, v196, s[96:97]
    v_cndmask_b32 v217, v217, v204, s[98:99]
    v_cndmask_b32 v217, v217, v212, s[100:101]
    ds_write_b64 v14, v[216:217]
    s_waitcnt lgkmcnt(0)
    s_barrier
    ds_read_b64 v[176:177], v15 offset:0
    ds_read_b64 v[178:179], v15 offset:512
    ds_read_b64 v[180:181], v15 offset:1024
    ds_read_b64 v[182:183], v15 offset:1536
    ds_read_b64 v[184:185], v15 offset:2048
    ds_read_b64 v[186:187], v15 offset:2560
    ds_read_b64 v[188:189], v15 offset:3072
    ds_read_b64 v[190:191], v15 offset:3584
    s_mov_b32 s96, 0x22222222
    s_mov_b32 s97, 0x22222222
    s_mov_b32 s98, 0x44444444
    s_mov_b32 s99, 0x44444444
    s_mov_b32 s100, 0x88888888
    s_mov_b32 s101, 0x88888888
    s_waitcnt lgkmcnt(0)
    v_add_f32 v176, v176, v178
    v_add_f32 v180, v180, v182
    v_add_f32 v184, v184, v186
    v_add_f32 v188, v188, v190
    v_add_f32 v176, v176, v180
    v_add_f32 v184, v184, v188
    v_add_f32 v176, v176, v184
    v_add_f32 v177, v177, v179
    v_add_f32 v181, v181, v183
    v_add_f32 v185, v185, v187
    v_add_f32 v189, v189, v191
    v_add_f32 v177, v177, v181
    v_add_f32 v185, v185, v189
    v_add_f32 v177, v177, v185
    v_cvt_pk_bf16_f32 v176, v176, v177
    ds_write_b32 v232, v176
    s_waitcnt lgkmcnt(0)
    ds_read_b128 v[180:183], v233 offset:0
    ds_read_b128 v[184:187], v233 offset:64
    ds_read_b128 v[188:191], v233 offset:128
    ds_read_b128 v[192:195], v233 offset:192
    s_waitcnt lgkmcnt(3)
    v_mfma_f32_16x16x32_bf16 v[196:199], v[16:19], v[180:183], 0
    v_mfma_f32_16x16x32_bf16 v[200:203], v[20:23], v[180:183], 0
    v_mfma_f32_16x16x32_bf16 v[204:207], v[24:27], v[180:183], 0
    v_mfma_f32_16x16x32_bf16 v[208:211], v[28:31], v[180:183], 0
    s_waitcnt lgkmcnt(2)
    v_mfma_f32_16x16x32_bf16 v[196:199], v[32:35], v[184:187], v[196:199]
    v_mfma_f32_16x16x32_bf16 v[200:203], v[36:39], v[184:187], v[200:203]
    v_mfma_f32_16x16x32_bf16 v[204:207], v[40:43], v[184:187], v[204:207]
    v_mfma_f32_16x16x32_bf16 v[208:211], v[44:47], v[184:187], v[208:211]
    s_waitcnt lgkmcnt(1)
    v_mfma_f32_16x16x32_bf16 v[196:199], v[48:51], v[188:191], v[196:199]
    v_mfma_f32_16x16x32_bf16 v[200:203], v[52:55], v[188:191], v[200:203]
    v_mfma_f32_16x16x32_bf16 v[204:207], v[56:59], v[188:191], v[204:207]
    v_mfma_f32_16x16x32_bf16 v[208:211], v[60:63], v[188:191], v[208:211]
    s_waitcnt lgkmcnt(0)
    v_mfma_f32_16x16x32_bf16 v[196:199], v[64:67], v[192:195], v[196:199]
    v_mfma_f32_16x16x32_bf16 v[200:203], v[68:71], v[192:195], v[200:203]
    v_mfma_f32_16x16x32_bf16 v[204:207], v[72:75], v[192:195], v[204:207]
    v_mfma_f32_16x16x32_bf16 v[208:211], v[76:79], v[192:195], v[208:211]
    s_nop 5
    v_cndmask_b32 v212, v196, v200, s[96:97]
    v_cndmask_b32 v212, v212, v204, s[98:99]
    v_cndmask_b32 v212, v212, v208, s[100:101]
    v_cndmask_b32 v213, v197, v201, s[96:97]
    v_cndmask_b32 v213, v213, v205, s[98:99]
    v_cndmask_b32 v213, v213, v209, s[100:101]
    v_cndmask_b32 v214, v198, v202, s[96:97]
    v_cndmask_b32 v214, v214, v206, s[98:99]
    v_cndmask_b32 v214, v214, v210, s[100:101]
    v_cndmask_b32 v215, v199, v203, s[96:97]
    v_cndmask_b32 v215, v215, v207, s[98:99]
    v_cndmask_b32 v215, v215, v211, s[100:101]
    v_cvt_pk_bf16_f32 v228, v212, v213
    v_cvt_pk_bf16_f32 v230, v214, v215
    s_mov_b64 exec, s[60:61]
    buffer_store_dwordx4 v[228:231], v234, s[8:11], s70 offen sc1
    s_mov_b64 exec, -1
    s_branch L_exit
L_qpost:
    s_lshr_b32 s53, s4, 2
    s_and_b32 s68, s4, 3
    s_cmp_eq_u32 s53, 3
    s_cbranch_scc1 L_final
    s_lshl_b32 s69, s53, 3
    s_add_u32 s69, s69, s3
    s_cmp_ge_u32 s69, 22
    s_cbranch_scc1 L_idle
    s_waitcnt vmcnt(0)
    s_barrier
    s_cmp_lg_u32 s5, 0
    s_cbranch_scc1 L_nofl_30
    s_mov_b64 exec, 0xffff
    buffer_store_dwordx2 v[238:239], v95, s[8:11], s71 offen sc1
    s_mov_b64 exec, -1
L_nofl_30:
    s_mov_b32 s12, s30
    s_mov_b32 s13, s31
    s_mov_b32 s14, 1409024
    s_mov_b32 s15, 0x00020000
    v_lshrrev_b32 v6, 3, v1
    v_mul_u32_u24 v6, 2752, v6
    v_and_b32 v7, 7, v1
    v_lshlrev_b32 v8, 1, v2
    v_xor_b32 v7, v7, v8
    v_lshl_add_u32 v6, v7, 4, v6
    v_add_u32 v7, 20992, v6
    v_add_u32 v8, 41984, v6
    v_add_u32 v9, 62976, v6
    s_mul_i32 s62, s5, 176128
    s_lshl_b32 s55, s69, 7
    s_add_u32 s62, s62, s55
    s_add_u32 s53, s62, 88064
    s_add_u32 s54, s52, 4096
    s_mov_b32 m0, s52
    s_nop 0
    buffer_load_dwordx4 v6, s[12:15], s62 offen lds
    buffer_load_dwordx4 v7, s[12:15], s62 offen offset:1024 lds
    buffer_load_dwordx4 v8, s[12:15], s62 offen offset:2048 lds
    buffer_load_dwordx4 v9, s[12:15], s62 offen offset:3072 lds
    s_mov_b32 m0, s54
    s_nop 0
    buffer_load_dwordx4 v6, s[12:15], s53 offen lds
    buffer_load_dwordx4 v7, s[12:15], s53 offen offset:1024 lds
    buffer_load_dwordx4 v8, s[12:15], s53 offen offset:2048 lds
    buffer_load_dwordx4 v9, s[12:15], s53 offen offset:3072 lds
    s_mov_b32 s44, s32
    s_mov_b32 s45, s33
    s_mov_b32 s46, 1409024
    s_mov_b32 s47, 0x00020000
    v_lshrrev_b32 v10, 3, v1
    v_mul_u32_u24 v10, 1024, v10
    v_and_b32 v11, 7, v1
    v_lshlrev_b32 v12, 1, v2
    v_xor_b32 v11, v11, v12
    v_lshl_add_u32 v10, v11, 4, v10
    v_add_u32 v11, 7168, v10
    v_add_u32 v12, 14336, v10
    v_add_u32 v13, 21504, v10
    s_lshl_b32 s62, s69, 16
    s_lshl_b32 s55, s5, 7
    s_add_u32 s62, s62, s55
    s_add_u32 s53, s62, 32768
    s_add_u32 s54, s52, 8192
    s_add_u32 s55, s52, 12288
    s_mov_b32 m0, s54
    s_nop 0
    buffer_load_dwordx4 v10, s[44:47], s62 offen lds
    buffer_load_dwordx4 v11, s[44:47], s62 offen offset:1024 lds
    buffer_load_dwordx4 v12, s[44:47], s62 offen offset:2048 lds
    buffer_load_dwordx4 v13, s[44:47], s62 offen offset:3072 lds
    s_mov_b32 m0, s55
    s_nop 0
    buffer_load_dwordx4 v10, s[44:47], s53 offen lds
    buffer_load_dwordx4 v11, s[44:47], s53 offen offset:1024 lds
    buffer_load_dwordx4 v12, s[44:47], s53 offen offset:2048 lds
    buffer_load_dwordx4 v13, s[44:47], s53 offen offset:3072 lds
    s_mov_b32 s48, s16
    s_mov_b32 s49, s17
    s_mov_b32 s50, 4096
    s_mov_b32 s51, 0x00020000
    v_lshlrev_b32 v5, 3, v3
    s_lshl_b32 s53, s68, 10
    s_lshl_b32 s54, s5, 7
    s_add_u32 s53, s53, s54
    buffer_load_dwordx2 v[100:101], v5, s[48:51], s53 offen
    v_lshlrev_b32 v5, 4, v3
    s_lshl_b32 s53, s68, 13
    s_lshl_b32 s54, s5, 8
    s_add_u32 s53, s53, s54
    s_add_u32 s53, s53, 5308416
    s_add_u32 s54, s53, 4096
    v_lshrrev_b32 v8, 2, v3
    v_lshl_add_u32 v8, v2, 2, v8
    v_lshrrev_b32 v9, 1, v8
    v_and_b32 v9, 3, v9
    v_lshlrev_b32 v9, 5, v9
    v_lshl_add_u32 v8, v8, 7, v9
    v_lshrrev_b32 v9, 1, v4
    v_lshl_add_u32 v8, v9, 4, v8
    v_and_b32 v9, 1, v4
    v_lshl_add_u32 v8, v9, 3, v8
    v_add_u32 v8, s52, v8
    v_xor_b32 v9, 32, v8
    v_xor_b32 v10, 64, v8
    v_xor_b32 v11, 96, v8
    s_mov_b32 s96, 0x22222222
    s_mov_b32 s97, 0x22222222
    s_mov_b32 s98, 0x44444444
    s_mov_b32 s99, 0x44444444
    s_mov_b32 s100, 0x88888888
    s_mov_b32 s101, 0x88888888
    s_lshl_b32 s72, s68, 16
    s_add_u32 s72, s72, 393216
    s_lshl_b32 s56, s5, 8
    s_add_u32 s73, s72, s56
    s_add_u32 s74, s73, 57344
    v_lshlrev_b32 v13, 4, v3
    v_lshl_add_u32 v13, v2, 11, v13
    s_lshl_b32 s55, s5, 3
    s_add_u32 s55, s55, 151552
    v_mov_b32 v220, s55
    v_and_b32 v221, 7, v1
    v_lshlrev_b32 v221, 3, v221
    v_add_u32 v221, 151552, v221
    v_lshrrev_b32 v222, 5, v1
    v_lshlrev_b32 v222, 6, v222
    v_lshrrev_b32 v223, 2, v1
    v_and_b32 v223, 3, v223
    v_lshl_add_u32 v222, v223, 4, v222
    v_and_b32 v223, 1, v2
    v_lshl_add_u32 v222, v223, 3, v222
    v_lshl_add_u32 v222, v4, 1, v222
    v_lshrrev_b32 v219, 3, v3
    v_lshlrev_b32 v219, 6, v219
    v_lshl_add_u32 v219, v4, 4, v219
    v_lshrrev_b32 v223, 2, v3
    v_and_b32 v223, 1, v223
    v_lshl_add_u32 v219, v223, 3, v219
    s_lshl_b32 s55, s5, 8
    s_add_u32 s55, s55, 147456
    v_add_u32 v222, s55, v222
    v_add_u32 v219, s55, v219
    v_lshl_add_u32 v223, v2, 4, s55
    s_lshl_b32 s55, s5, 8
    s_add_u32 s55, s55, 159232
    v_lshlrev_b32 v224, 6, v3
    v_lshl_add_u32 v224, v2, 4, v224
    v_add_u32 v224, s55, v224
    v_lshlrev_b32 v225, 2, v1
    v_add_u32 v225, 159232, v225
    s_lshl_b32 s55, s68, 3
    s_add_u32 s55, s55, s5
    s_mul_i32 s55, s55, 6144
    s_lshl_b32 s56, s69, 8
    s_add_u32 s55, s55, s56
    s_add_u32 s75, s55, 655360
    v_lshlrev_b32 v226, 6, v3
    v_lshl_add_u32 v226, v2, 4, v226
    s_lshl_b32 s55, s69, 6
    v_add_u32 v227, s55, v1
    s_movk_i32 s56, 1376
    v_cmp_gt_u32 s[62:63], s56, v227
    v_mov_b32 v141, s6
    v_mov_b32 v143, s6
    s_waitcnt vmcnt(0)
    ds_read_b64_tr_b16 v[16:17], v8 offset:0
    ds_read_b64_tr_b16 v[18:19], v8 offset:2048
    ds_read_b64_tr_b16 v[20:21], v9 offset:0
    ds_read_b64_tr_b16 v[22:23], v9 offset:2048
    ds_read_b64_tr_b16 v[24:25], v10 offset:0
    ds_read_b64_tr_b16 v[26:27], v10 offset:2048
    ds_read_b64_tr_b16 v[28:29], v11 offset:0
    ds_read_b64_tr_b16 v[30:31], v11 offset:2048
    ds_read_b64_tr_b16 v[32:33], v8 offset:4096
    ds_read_b64_tr_b16 v[34:35], v8 offset:6144
    ds_read_b64_tr_b16 v[36:37], v9 offset:4096
    ds_read_b64_tr_b16 v[38:39], v9 offset:6144
    ds_read_b64_tr_b16 v[40:41], v10 offset:4096
    ds_read_b64_tr_b16 v[42:43], v10 offset:6144
    ds_read_b64_tr_b16 v[44:45], v11 offset:4096
    ds_read_b64_tr_b16 v[46:47], v11 offset:6144
    ds_read_b64_tr_b16 v[48:49], v8 offset:8192
    ds_read_b64_tr_b16 v[50:51], v8 offset:10240
    ds_read_b64_tr_b16 v[52:53], v9 offset:8192
    ds_read_b64_tr_b16 v[54:55], v9 offset:10240
    ds_read_b64_tr_b16 v[56:57], v10 offset:8192
    ds_read_b64_tr_b16 v[58:59], v10 offset:10240
    ds_read_b64_tr_b16 v[60:61], v11 offset:8192
    ds_read_b64_tr_b16 v[62:63], v11 offset:10240
    ds_read_b64_tr_b16 v[64:65], v8 offset:12288
    ds_read_b64_tr_b16 v[66:67], v8 offset:14336
    ds_read_b64_tr_b16 v[68:69], v9 offset:12288
    ds_read_b64_tr_b16 v[70:71], v9 offset:14336
    ds_read_b64_tr_b16 v[72:73], v10 offset:12288
    ds_read_b64_tr_b16 v[74:75], v10 offset:14336
    ds_read_b64_tr_b16 v[76:77], v11 offset:12288
    ds_read_b64_tr_b16 v[78:79], v11 offset:14336
    s_mov_b32 s59, 20000
L_poll_31:
    buffer_load_dwordx4 v[84:87], v5, s[8:11], s53 offen sc1
    buffer_load_dwordx4 v[88:91], v5, s[8:11], s53 offen offset:2048 sc1
    buffer_load_dwordx4 v[92:95], v5, s[8:11], s54 offen sc1
    s_waitcnt vmcnt(0)
    v_xor_b32 v208, s6, v85
    v_bitop3_b32 v208, v208, v87, s6 bitop3:0xf6
    v_bitop3_b32 v208, v208, v89, s6 bitop3:0xf6
    v_bitop3_b32 v208, v208, v91, s6 bitop3:0xf6
    v_bitop3_b32 v208, v208, v93, s6 bitop3:0xf6
    v_bitop3_b32 v208, v208, v95, s6 bitop3:0xf6
    v_cmp_ne_u32 vcc, 0, v208
    s_cbranch_vccz L_ok_32
    s_sub_u32 s59, s59, 1
    s_cbranch_scc1 L_fail_5
    s_sleep 16
    s_branch L_poll_31
L_ok_32:
    v_lshlrev_b32 v96, 16, v100
    v_and_b32 v97, 0xffff0000, v100
    v_lshlrev_b32 v98, 16, v101
    v_and_b32 v99, 0xffff0000, v101
    v_lshlrev_b32 v100, 16, v84
    v_and_b32 v101, 0xffff0000, v84
    v_lshlrev_b32 v102, 16, v86
    v_and_b32 v103, 0xffff0000, v86
    v_lshlrev_b32 v104, 16, v88
    v_and_b32 v105, 0xffff0000, v88
    v_lshlrev_b32 v106, 16, v90
    v_and_b32 v107, 0xffff0000, v90
    v_lshlrev_b32 v108, 16, v92
    v_and_b32 v109, 0xffff0000, v92
    v_lshlrev_b32 v110, 16, v94
    v_and_b32 v111, 0xffff0000, v94
    s_mov_b32 s53, 0x00003f80
    s_mov_b32 s54, 0x3f800000
    s_mov_b32 s59, 20000
L_poll_33:
    buffer_load_dwordx4 v[204:207], v13, s[8:11], s74 offen sc1
    s_waitcnt vmcnt(0)
    v_xor_b32 v208, s6, v205
    v_bitop3_b32 v208, v208, v207, s6 bitop3:0xf6
    v_cmp_ne_u32 vcc, 0, v208
    s_cbranch_vccz L_ok_34
    s_sub_u32 s59, s59, 1
    s_cbranch_scc1 L_fail_6
    s_sleep 1
    s_branch L_poll_33
L_ok_34:
    s_mov_b32 s59, 20000
L_poll_35:
    s_mov_b32 s55, s73
    buffer_load_dwordx4 v[176:179], v13, s[8:11], s55 offen sc1
    s_add_u32 s55, s55, 8192
    buffer_load_dwordx4 v[180:183], v13, s[8:11], s55 offen sc1
    s_add_u32 s55, s55, 8192
    buffer_load_dwordx4 v[184:187], v13, s[8:11], s55 offen sc1
    s_add_u32 s55, s55, 8192
    buffer_load_dwordx4 v[188:191], v13, s[8:11], s55 offen sc1
    s_add_u32 s55, s55, 8192
    buffer_load_dwordx4 v[192:195], v13, s[8:11], s55 offen sc1
    s_add_u32 s55, s55, 8192
    buffer_load_dwordx4 v[196:199], v13, s[8:11], s55 offen sc1
    s_add_u32 s55, s55, 8192
    buffer_load_dwordx4 v[200:203], v13, s[8:11], s55 offen sc1
    s_add_u32 s55, s55, 8192
    buffer_load_dwordx4 v[204:207], v13, s[8:11], s55 offen sc1
    s_waitcnt vmcnt(7)
    v_dot2_f32_bf16 v112, v176, s53, 0
    v_dot2_f32_bf16 v113, v176, s54, 0
    v_dot2_f32_bf16 v114, v178, s53, 0
    v_dot2_f32_bf16 v115, v178, s54, 0
    v_xor_b32 v208, s6, v177
    v_bitop3_b32 v208, v208, v179, s6 bitop3:0xf6
    s_waitcnt vmcnt(6)
    v_dot2_f32_bf16 v112, v180, s53, v112
    v_dot2_f32_bf16 v113, v180, s54, v113
    v_dot2_f32_bf16 v114, v182, s53, v114
    v_dot2_f32_bf16 v115, v182, s54, v115
    v_bitop3_b32 v208, v208, v181, s6 bitop3:0xf6
    v_bitop3_b32 v208, v208, v183, s6 bitop3:0xf6
    s_waitcnt vmcnt(5)
    v_dot2_f32_bf16 v112, v184, s53, v112
    v_dot2_f32_bf16 v113, v184, s54, v113
    v_dot2_f32_bf16 v114, v186, s53, v114
    v_dot2_f32_bf16 v115, v186, s54, v115
    v_bitop3_b32 v208, v208, v185, s6 bitop3:0xf6
    v_bitop3_b32 v208, v208, v187, s6 bitop3:0xf6
    s_waitcnt vmcnt(4)
    v_dot2_f32_bf16 v112, v188, s53, v112
    v_dot2_f32_bf16 v113, v188, s54, v113
    v_dot2_f32_bf16 v114, v190, s53, v114
    v_dot2_f32_bf16 v115, v190, s54, v115
    v_bitop3_b32 v208, v208, v189, s6 bitop3:0xf6
    v_bitop3_b32 v208, v208, v191, s6 bitop3:0xf6
    s_waitcnt vmcnt(3)
    v_dot2_f32_bf16 v112, v192, s53, v112
    v_dot2_f32_bf16 v113, v192, s54, v113
    v_dot2_f32_bf16 v114, v194, s53, v114
    v_dot2_f32_bf16 v115, v194, s54, v115
    v_bitop3_b32 v208, v208, v193, s6 bitop3:0xf6
    v_bitop3_b32 v208, v208, v195, s6 bitop3:0xf6
    s_waitcnt vmcnt(2)
    v_dot2_f32_bf16 v112, v196, s53, v112
    v_dot2_f32_bf16 v113, v196, s54, v113
    v_dot2_f32_bf16 v114, v198, s53, v114
    v_dot2_f32_bf16 v115, v198, s54, v115
    v_bitop3_b32 v208, v208, v197, s6 bitop3:0xf6
    v_bitop3_b32 v208, v208, v199, s6 bitop3:0xf6
    s_waitcnt vmcnt(1)
    v_dot2_f32_bf16 v112, v200, s53, v112
    v_dot2_f32_bf16 v113, v200, s54, v113
    v_dot2_f32_bf16 v114, v202, s53, v114
    v_dot2_f32_bf16 v115, v202, s54, v115
    v_bitop3_b32 v208, v208, v201, s6 bitop3:0xf6
    v_bitop3_b32 v208, v208, v203, s6 bitop3:0xf6
    s_waitcnt vmcnt(0)
    v_dot2_f32_bf16 v112, v204, s53, v112
    v_dot2_f32_bf16 v113, v204, s54, v113
    v_dot2_f32_bf16 v114, v206, s53, v114
    v_dot2_f32_bf16 v115, v206, s54, v115
    v_bitop3_b32 v208, v208, v205, s6 bitop3:0xf6
    v_bitop3_b32 v208, v208, v207, s6 bitop3:0xf6
    v_cmp_ne_u32 vcc, 0, v208
    s_cbranch_vccz L_ok_36
    s_sub_u32 s59, s59, 1
    s_cbranch_scc1 L_fail_7
    s_sleep 1
    s_branch L_poll_35
L_ok_36:
    v_mov_b32 v116, v112
    v_mov_b32 v117, v113
    v_mov_b32 v118, v114
    v_mov_b32 v119, v115
    v_permlane16_swap_b32 v112, v116
    v_permlane16_swap_b32 v113, v117
    v_permlane16_swap_b32 v114, v118
    v_permlane16_swap_b32 v115, v119
    v_add_f32 v112, v112, v116
    v_add_f32 v113, v113, v117
    v_add_f32 v114, v114, v118
    v_add_f32 v115, v115, v119
    v_mov_b32 v116, v112
    v_mov_b32 v117, v113
    v_mov_b32 v118, v114
    v_mov_b32 v119, v115
    v_permlane32_swap_b32 v112, v116
    v_permlane32_swap_b32 v113, v117
    v_permlane32_swap_b32 v114, v118
    v_permlane32_swap_b32 v115, v119
    v_add_f32 v112, v112, v116
    v_add_f32 v113, v113, v117
    v_add_f32 v114, v114, v118
    v_add_f32 v115, v115, v119
    v_fmac_f32 v96, v100, v112
    v_fmac_f32 v97, v101, v113
    v_fmac_f32 v98, v102, v114
    v_fmac_f32 v99, v103, v115
    v_add_f32 v120, v96, v97
    v_add_f32 v122, v98, v99
    v_mul_f32 v121, v96, v96
    v_fmac_f32 v121, v97, v97
    v_fmac_f32 v121, v98, v98
    v_fmac_f32 v121, v99, v99
    v_add_f32 v120, v120, v122
    s_nop 1
    v_add_f32_dpp v120, v120, v120 row_ror:8 row_mask:0xf bank_mask:0xf
    v_add_f32_dpp v121, v121, v121 row_ror:8 row_mask:0xf bank_mask:0xf
    s_nop 0
    v_add_f32_dpp v120, v120, v120 row_ror:4 row_mask:0xf bank_mask:0xf
    v_add_f32_dpp v121, v121, v121 row_ror:4 row_mask:0xf bank_mask:0xf
    s_nop 0
    v_add_f32_dpp v120, v120, v120 row_ror:2 row_mask:0xf bank_mask:0xf
    v_add_f32_dpp v121, v121, v121 row_ror:2 row_mask:0xf bank_mask:0xf
    s_nop 0
    v_add_f32_dpp v120, v120, v120 row_ror:1 row_mask:0xf bank_mask:0xf
    v_add_f32_dpp v121, v121, v121 row_ror:1 row_mask:0xf bank_mask:0xf
    ds_write_b64 v220, v[120:121]
    s_waitcnt lgkmcnt(0)
    s_barrier
    ds_read_b64 v[112:113], v221
    s_waitcnt lgkmcnt(0)
    v_add_f32_dpp v112, v112, v112 quad_perm:[1,0,3,2] row_mask:0xf bank_mask:0xf
    v_add_f32_dpp v113, v113, v113 quad_perm:[1,0,3,2] row_mask:0xf bank_mask:0xf
    s_nop 0
    v_add_f32_dpp v112, v112, v112 quad_perm:[2,3,0,1] row_mask:0xf bank_mask:0xf
    v_add_f32_dpp v113, v113, v113 quad_perm:[2,3,0,1] row_mask:0xf bank_mask:0xf
    s_nop 0
    v_add_f32_dpp v112, v112, v112 row_half_mirror row_mask:0xf bank_mask:0xf
    v_add_f32_dpp v113, v113, v113 row_half_mirror row_mask:0xf bank_mask:0xf
    v_mul_f32 v112, 0x3b000000, v112
    v_mul_f32 v113, 0x3b000000, v113
    v_fma_f32 v113, -v112, v112, v113
    v_max_f32 v113, 0, v113
    v_add_f32 v113, 0x3727c5ac, v113
    v_rsq_f32 v113, v113
    v_sub_f32 v96, v96, v112
    v_sub_f32 v97, v97, v112
    v_sub_f32 v98, v98, v112
    v_sub_f32 v99, v99, v112
    v_mul_f32 v96, v96, v113
    v_mul_f32 v97, v97, v113
    v_mul_f32 v98, v98, v113
    v_mul_f32 v99, v99, v113
    v_add_f32 v104, v104, v96
    v_add_f32 v105, v105, v97
    v_add_f32 v106, v106, v98
    v_add_f32 v107, v107, v99
    v_fmac_f32 v104, v96, v108
    v_fmac_f32 v105, v97, v109
    v_fmac_f32 v106, v98, v110
    v_fmac_f32 v107, v99, v111
    v_cvt_pk_bf16_f32 v104, v104, v105
    v_cvt_pk_bf16_f32 v105, v106, v107
    ds_write_b64 v219, v[104:105]
    s_waitcnt lgkmcnt(0)
    ds_read_b128 v[112:115], v223
    ds_read_b128 v[116:119], v223 offset:64
    s_waitcnt lgkmcnt(1)
    v_mfma_f32_16x16x32_bf16 v[120:123], v[16:19], v[112:115], 0
    v_mfma_f32_16x16x32_bf16 v[124:127], v[20:23], v[112:115], 0
    v_mfma_f32_16x16x32_bf16 v[128:131], v[24:27], v[112:115], 0
    v_mfma_f32_16x16x32_bf16 v[132:135], v[28:31], v[112:115], 0
    s_waitcnt lgkmcnt(0)
    v_mfma_f32_16x16x32_bf16 v[120:123], v[32:35], v[116:119], v[120:123]
    v_mfma_f32_16x16x32_bf16 v[124:127], v[36:39], v[116:119], v[124:127]
    v_mfma_f32_16x16x32_bf16 v[128:131], v[40:43], v[116:119], v[128:131]
    v_mfma_f32_16x16x32_bf16 v[132:135], v[44:47], v[116:119], v[132:135]
    s_nop 5
    v_cndmask_b32 v136, v120, v124, s[96:97]
    v_cndmask_b32 v136, v136, v128, s[98:99]
    v_cndmask_b32 v136, v136, v132, s[100:101]
    v_cndmask_b32 v137, v121, v125, s[96:97]
    v_cndmask_b32 v137, v137, v129, s[98:99]
    v_cndmask_b32 v137, v137, v133, s[100:101]
    v_cndmask_b32 v138, v122, v126, s[96:97]
    v_cndmask_b32 v138, v138, v130, s[98:99]
    v_cndmask_b32 v138, v138, v134, s[100:101]
    v_cndmask_b32 v139, v123, v127, s[96:97]
    v_cndmask_b32 v139, v139, v131, s[98:99]
    v_cndmask_b32 v139, v139, v135, s[100:101]
    s_mov_b64 exec, s[60:61]
    ds_write_b128 v224, v[136:139]
    s_mov_b64 exec, -1
    s_waitcnt lgkmcnt(0)
    s_barrier
    ds_read_b32 v112, v225 offset:0
    ds_read_b32 v113, v225 offset:256
    ds_read_b32 v114, v225 offset:512
    ds_read_b32 v115, v225 offset:768
    ds_read_b32 v116, v225 offset:1024
    ds_read_b32 v117, v225 offset:1280
    ds_read_b32 v118, v225 offset:1536
    ds_read_b32 v119, v225 offset:1792
    s_waitcnt lgkmcnt(0)
    v_add_f32 v112, v112, v113
    v_add_f32 v114, v114, v115
    v_add_f32 v116, v116, v117
    v_add_f32 v118, v118, v119
    v_add_f32 v112, v112, v114
    v_add_f32 v116, v116, v118
    v_add_f32 v112, v112, v116
    v_max_f32 v112, 0, v112
    v_cndmask_b32 v112, 0, v112, s[62:63]
    v_cvt_pk_bf16_f32 v112, v112, v112
    ds_write_b16 v222, v112 offset:128
    s_waitcnt lgkmcnt(0)
    ds_read_b128 v[112:115], v223 offset:128
    ds_read_b128 v[116:119], v223 offset:192
    s_waitcnt lgkmcnt(1)
    v_mfma_f32_16x16x32_bf16 v[120:123], v[48:51], v[112:115], 0
    v_mfma_f32_16x16x32_bf16 v[124:127], v[52:55], v[112:115], 0
    v_mfma_f32_16x16x32_bf16 v[128:131], v[56:59], v[112:115], 0
    v_mfma_f32_16x16x32_bf16 v[132:135], v[60:63], v[112:115], 0
    s_waitcnt lgkmcnt(0)
    v_mfma_f32_16x16x32_bf16 v[120:123], v[64:67], v[116:119], v[120:123]
    v_mfma_f32_16x16x32_bf16 v[124:127], v[68:71], v[116:119], v[124:127]
    v_mfma_f32_16x16x32_bf16 v[128:131], v[72:75], v[116:119], v[128:131]
    v_mfma_f32_16x16x32_bf16 v[132:135], v[76:79], v[116:119], v[132:135]
    s_nop 5
    v_cndmask_b32 v136, v120, v124, s[96:97]
    v_cndmask_b32 v136, v136, v128, s[98:99]
    v_cndmask_b32 v136, v136, v132, s[100:101]
    v_cndmask_b32 v137, v121, v125, s[96:97]
    v_cndmask_b32 v137, v137, v129, s[98:99]
    v_cndmask_b32 v137, v137, v133, s[100:101]
    v_cndmask_b32 v138, v122, v126, s[96:97]
    v_cndmask_b32 v138, v138, v130, s[98:99]
    v_cndmask_b32 v138, v138, v134, s[100:101]
    v_cndmask_b32 v139, v123, v127, s[96:97]
    v_cndmask_b32 v139, v139, v131, s[98:99]
    v_cndmask_b32 v139, v139, v135, s[100:101]
    v_cvt_pk_bf16_f32 v140, v136, v137
    v_cvt_pk_bf16_f32 v142, v138, v139
    s_mov_b64 exec, s[60:61]
    buffer_store_dwordx4 v[140:143], v226, s[8:11], s75 offen sc1
    s_mov_b64 exec, -1
    s_branch L_exit
L_final:
    s_waitcnt vmcnt(0)
    s_barrier
    s_cmp_lg_u32 s5, 0
    s_cbranch_scc1 L_nofl_37
    s_mov_b64 exec, 0xffff
    buffer_store_dwordx2 v[238:239], v95, s[8:11], s71 offen sc1
    s_mov_b64 exec, -1
L_nofl_37:
    s_lshl_b32 s69, s3, 2
    s_add_u32 s69, s69, s68
    v_lshlrev_b32 v16, 3, v0
    v_lshrrev_b32 v20, 7, v0
    v_mul_u32_u24 v20, 1088, v20
    v_and_b32 v21, 127, v0
    v_lshrrev_b32 v21, 3, v21
    v_lshl_add_u32 v20, v21, 6, v20
    v_and_b32 v21, 3, v0
    v_lshl_add_u32 v20, v21, 4, v20
    v_lshrrev_b32 v21, 2, v0
    v_and_b32 v21, 1, v21
    v_lshl_add_u32 v20, v21, 3, v20
    v_add_u32 v20, 152576, v20
    s_mov_b32 s44, s34
    s_mov_b32 s45, s35
    s_mov_b32 s46, 4096
    s_mov_b32 s47, 0x00020000
    buffer_load_dwordx2 v[18:19], v16, s[44:47], 0 offen
    s_mov_b32 s12, s36
    s_mov_b32 s13, s37
    s_mov_b32 s14, 3145728
    s_mov_b32 s15, 0x00020000
    v_lshrrev_b32 v6, 3, v1
    v_mul_u32_u24 v6, 6144, v6
    v_and_b32 v7, 7, v1
    v_lshlrev_b32 v8, 1, v2
    v_xor_b32 v7, v7, v8
    v_lshl_add_u32 v6, v7, 4, v6
    v_add_u32 v7, 48128, v6
    v_add_u32 v8, 96256, v6
    v_add_u32 v9, 144384, v6
    s_mul_i32 s62, s5, 393216
    s_lshl_b32 s55, s69, 7
    s_add_u32 s62, s62, s55
    s_add_u32 s62, s62, 2048
    s_add_u32 s53, s62, 196608
    s_add_u32 s54, s52, 4096
    s_mov_b32 m0, s52
    s_nop 0
    buffer_load_dwordx4 v6, s[12:15], s62 offen lds
    buffer_load_dwordx4 v7, s[12:15], s62 offen offset:1024 lds
    buffer_load_dwordx4 v8, s[12:15], s62 offen offset:2048 lds
    buffer_load_dwordx4 v9, s[12:15], s62 offen offset:3072 lds
    s_mov_b32 m0, s54
    s_nop 0
    buffer_load_dwordx4 v6, s[12:15], s53 offen lds
    buffer_load_dwordx4 v7, s[12:15], s53 offen offset:1024 lds
    buffer_load_dwordx4 v8, s[12:15], s53 offen offset:2048 lds
    buffer_load_dwordx4 v9, s[12:15], s53 offen offset:3072 lds
    v_mul_u32_u24 v12, 1088, v4
    v_lshl_add_u32 v12, v2, 4, v12
    s_lshl_b32 s55, s5, 7
    s_add_u32 s55, s55, 152576
    v_add_u32 v12, s55, v12
    v_lshrrev_b32 v8, 2, v3
    v_lshl_add_u32 v8, v2, 2, v8
    v_lshrrev_b32 v9, 1, v8
    v_and_b32 v9, 3, v9
    v_lshlrev_b32 v9, 5, v9
    v_lshl_add_u32 v8, v8, 7, v9
    v_lshrrev_b32 v9, 1, v4
    v_lshl_add_u32 v8, v9, 4, v8
    v_and_b32 v9, 1, v4
    v_lshl_add_u32 v8, v9, 3, v8
    v_add_u32 v8, s52, v8
    v_xor_b32 v9, 32, v8
    v_xor_b32 v10, 64, v8
    v_xor_b32 v11, 96, v8
    s_waitcnt vmcnt(8)
    v_lshlrev_b32 v22, 16, v18
    v_and_b32 v23, 0xffff0000, v18
    v_lshlrev_b32 v24, 16, v19
    v_and_b32 v25, 0xffff0000, v19
    v_mul_f32 v26, 0xbfb8aa3b, v22
    v_mul_f32 v27, 0xbfb8aa3b, v23
    v_mul_f32 v28, 0xbfb8aa3b, v24
    v_mul_f32 v29, 0xbfb8aa3b, v25
    v_exp_f32 v26, v26
    v_exp_f32 v27, v27
    v_exp_f32 v28, v28
    v_exp_f32 v29, v29
    v_add_f32 v26, 1.0, v26
    v_add_f32 v27, 1.0, v27
    v_add_f32 v28, 1.0, v28
    v_add_f32 v29, 1.0, v29
    v_rcp_f32 v26, v26
    v_rcp_f32 v27, v27
    v_rcp_f32 v28, v28
    v_rcp_f32 v29, v29
    v_mul_f32 v22, v22, v26
    v_mul_f32 v23, v23, v27
    v_mul_f32 v24, v24, v28
    v_mul_f32 v25, v25, v29
    v_cvt_pk_bf16_f32 v22, v22, v23
    v_cvt_pk_bf16_f32 v23, v24, v25
    ds_write_b64 v20, v[22:23]
    s_waitcnt lgkmcnt(0)
    s_barrier
    ds_read_b128 v[112:115], v12
    ds_read_b128 v[116:119], v12 offset:64
    s_waitcnt vmcnt(0)
    ds_read_b64_tr_b16 v[24:25], v8 offset:0
    ds_read_b64_tr_b16 v[26:27], v8 offset:2048
    ds_read_b64_tr_b16 v[28:29], v9 offset:0
    ds_read_b64_tr_b16 v[30:31], v9 offset:2048
    ds_read_b64_tr_b16 v[32:33], v10 offset:0
    ds_read_b64_tr_b16 v[34:35], v10 offset:2048
    ds_read_b64_tr_b16 v[36:37], v11 offset:0
    ds_read_b64_tr_b16 v[38:39], v11 offset:2048
    ds_read_b64_tr_b16 v[40:41], v8 offset:4096
    ds_read_b64_tr_b16 v[42:43], v8 offset:6144
    ds_read_b64_tr_b16 v[44:45], v9 offset:4096
    ds_read_b64_tr_b16 v[46:47], v9 offset:6144
    ds_read_b64_tr_b16 v[48:49], v10 offset:4096
    ds_read_b64_tr_b16 v[50:51], v10 offset:6144
    ds_read_b64_tr_b16 v[52:53], v11 offset:4096
    ds_read_b64_tr_b16 v[54:55], v11 offset:6144
    s_waitcnt lgkmcnt(0)
    v_mfma_f32_16x16x32_bf16 v[120:123], v[24:27], v[112:115], 0
    v_mfma_f32_16x16x32_bf16 v[124:127], v[28:31], v[112:115], 0
    v_mfma_f32_16x16x32_bf16 v[128:131], v[32:35], v[112:115], 0
    v_mfma_f32_16x16x32_bf16 v[132:135], v[36:39], v[112:115], 0
    v_mfma_f32_16x16x32_bf16 v[120:123], v[40:43], v[116:119], v[120:123]
    v_mfma_f32_16x16x32_bf16 v[124:127], v[44:47], v[116:119], v[124:127]
    v_mfma_f32_16x16x32_bf16 v[128:131], v[48:51], v[116:119], v[128:131]
    v_mfma_f32_16x16x32_bf16 v[132:135], v[52:55], v[116:119], v[132:135]
    s_lshl_b32 s53, s5, 10
    s_add_u32 s53, s53, 131072
    v_lshlrev_b32 v5, 6, v2
    v_lshl_add_u32 v5, v3, 4, v5
    v_add_u32 v5, s53, v5
    s_mov_b64 exec, s[60:61]
    ds_write_b128 v5, v[120:123] offset:0
    ds_write_b128 v5, v[124:127] offset:256
    ds_write_b128 v5, v[128:131] offset:512
    ds_write_b128 v5, v[132:135] offset:768
    s_mov_b64 exec, -1
    s_waitcnt lgkmcnt(0)
    s_barrier
    s_cmp_ge_u32 s5, 2
    s_cbranch_scc1 L_mrskip_38
    v_lshlrev_b32 v5, 3, v0
    v_add_u32 v5, 131072, v5
    ds_read_b64 v[112:113], v5 offset:0
    ds_read_b64 v[114:115], v5 offset:1024
    ds_read_b64 v[116:117], v5 offset:2048
    ds_read_b64 v[118:119], v5 offset:3072
    ds_read_b64 v[120:121], v5 offset:4096
    ds_read_b64 v[122:123], v5 offset:5120
    ds_read_b64 v[124:125], v5 offset:6144
    ds_read_b64 v[126:127], v5 offset:7168
    v_lshrrev_b32 v6, 1, v0
    v_and_b32 v6, 3, v6
    v_lshlrev_b32 v6, 13, v6
    v_lshrrev_b32 v7, 3, v0
    v_lshl_add_u32 v6, v7, 4, v6
    v_and_b32 v7, 1, v0
    v_lshl_add_u32 v6, v7, 3, v6
    s_lshl_b32 s53, s69, 8
    s_add_u32 s53, s53, 5308416
    s_waitcnt lgkmcnt(0)
    v_add_f32 v112, v112, v114
    v_add_f32 v116, v116, v118
    v_add_f32 v120, v120, v122
    v_add_f32 v124, v124, v126
    v_add_f32 v112, v112, v116
    v_add_f32 v120, v120, v124
    v_add_f32 v112, v112, v120
    v_add_f32 v113, v113, v115
    v_add_f32 v117, v117, v119
    v_add_f32 v121, v121, v123
    v_add_f32 v125, v125, v127
    v_add_f32 v113, v113, v117
    v_add_f32 v121, v121, v125
    v_add_f32 v113, v113, v121
    v_cvt_pk_bf16_f32 v112, v112, v113
    v_mov_b32 v113, s6
    buffer_store_dwordx2 v[112:113], v6, s[8:11], s53 offen sc1
L_mrskip_38:
    s_cmp_lg_u32 s5, 0
    s_cbranch_scc1 L_exit
    s_mov_b32 s48, s16
    s_mov_b32 s49, s17
    s_mov_b32 s50, 4096
    s_mov_b32 s51, 0x00020000
    s_mov_b32 s12, s38
    s_mov_b32 s13, s39
    s_mov_b32 s14, 4096
    s_mov_b32 s15, 0x00020000
    v_lshlrev_b32 v6, 3, v3
    s_lshl_b32 s53, s68, 10
    s_lshl_b32 s54, s3, 7
    s_add_u32 s70, s53, s54
    buffer_load_dwordx2 v[100:101], v6, s[48:51], s70 offen
    v_lshlrev_b32 v7, 4, v3
    s_lshl_b32 s53, s68, 13
    s_lshl_b32 s54, s3, 8
    s_add_u32 s62, s53, s54
    s_add_u32 s62, s62, 5308416
    s_add_u32 s63, s62, 6144
    v_lshl_add_u32 v9, v2, 11, v7
    s_lshl_b32 s75, s68, 16
    s_add_u32 s75, s75, 393216
    s_add_u32 s53, s75, s54
    v_lshl_add_u32 v11, v2, 8, v7
    v_and_b32 v12, 31, v1
    v_lshlrev_b32 v12, 11, v12
    v_add_u32 v12, 2040, v12
    s_lshl_b32 s72, s68, 3
    s_add_u32 s72, s72, s3
    s_mul_i32 s72, s72, 6144
    s_add_u32 s72, s72, 655360
    s_add_u32 s73, s72, 4096
    s_mov_b32 s98, 0x00003f80
    s_mov_b32 s99, 0x3f800000
    v_cmp_gt_u32 s[100:101], 2, v2
    s_mov_b32 s59, 20000
L_poll_39:
    buffer_load_dwordx2 v[112:113], v12, s[8:11], s75 offen sc1
    s_waitcnt vmcnt(0)
    v_xor_b32 v10, s6, v113
    v_cmp_ne_u32 vcc, 0, v10
    s_cbranch_vccz L_ok_40
    s_sub_u32 s59, s59, 1
    s_cbranch_scc1 L_fail_12
    s_sleep 3
    s_branch L_poll_39
L_ok_40:
    s_mov_b32 s59, 20000
L_poll_41:
    buffer_load_dwordx4 v[104:107], v7, s[8:11], s62 offen sc1
    buffer_load_dwordx4 v[108:111], v7, s[8:11], s63 offen sc1
    s_mov_b32 s54, s53
    buffer_load_dwordx4 v[112:115], v9, s[8:11], s54 offen sc1
    s_add_u32 s54, s54, 8192
    buffer_load_dwordx4 v[116:119], v9, s[8:11], s54 offen sc1
    s_add_u32 s54, s54, 8192
    buffer_load_dwordx4 v[120:123], v9, s[8:11], s54 offen sc1
    s_add_u32 s54, s54, 8192
    buffer_load_dwordx4 v[124:127], v9, s[8:11], s54 offen sc1
    s_add_u32 s54, s54, 8192
    buffer_load_dwordx4 v[128:131], v9, s[8:11], s54 offen sc1
    s_add_u32 s54, s54, 8192
    buffer_load_dwordx4 v[132:135], v9, s[8:11], s54 offen sc1
    s_add_u32 s54, s54, 8192
    buffer_load_dwordx4 v[136:139], v9, s[8:11], s54 offen sc1
    s_add_u32 s54, s54, 8192
    buffer_load_dwordx4 v[140:143], v9, s[8:11], s54 offen sc1
    s_waitcnt vmcnt(0)
    v_xor_b32 v10, s6, v105
    v_bitop3_b32 v10, v10, v107, s6 bitop3:0xf6
    v_bitop3_b32 v10, v10, v109, s6 bitop3:0xf6
    v_bitop3_b32 v10, v10, v111, s6 bitop3:0xf6
    v_bitop3_b32 v10, v10, v113, s6 bitop3:0xf6
    v_bitop3_b32 v10, v10, v115, s6 bitop3:0xf6
    v_bitop3_b32 v10, v10, v117, s6 bitop3:0xf6
    v_bitop3_b32 v10, v10, v119, s6 bitop3:0xf6
    v_bitop3_b32 v10, v10, v121, s6 bitop3:0xf6
    v_bitop3_b32 v10, v10, v123, s6 bitop3:0xf6
    v_bitop3_b32 v10, v10, v125, s6 bitop3:0xf6
    v_bitop3_b32 v10, v10, v127, s6 bitop3:0xf6
    v_bitop3_b32 v10, v10, v129, s6 bitop3:0xf6
    v_bitop3_b32 v10, v10, v131, s6 bitop3:0xf6
    v_bitop3_b32 v10, v10, v133, s6 bitop3:0xf6
    v_bitop3_b32 v10, v10, v135, s6 bitop3:0xf6
    v_bitop3_b32 v10, v10, v137, s6 bitop3:0xf6
    v_bitop3_b32 v10, v10, v139, s6 bitop3:0xf6
    v_bitop3_b32 v10, v10, v141, s6 bitop3:0xf6
    v_bitop3_b32 v10, v10, v143, s6 bitop3:0xf6
    v_cmp_ne_u32 vcc, 0, v10
    s_cbranch_vccz L_ok_42
    s_sub_u32 s59, s59, 1
    s_cbranch_scc1 L_fail_9
    s_sleep 2
    s_branch L_poll_41
L_ok_42:
    v_dot2_f32_bf16 v144, v112, s98, 0
    v_dot2_f32_bf16 v145, v112, s99, 0
    v_dot2_f32_bf16 v146, v114, s98, 0
    v_dot2_f32_bf16 v147, v114, s99, 0
    v_dot2_f32_bf16 v144, v116, s98, v144
    v_dot2_f32_bf16 v145, v116, s99, v145
    v_dot2_f32_bf16 v146, v118, s98, v146
    v_dot2_f32_bf16 v147, v118, s99, v147
    v_dot2_f32_bf16 v144, v120, s98, v144
    v_dot2_f32_bf16 v145, v120, s99, v145
    v_dot2_f32_bf16 v146, v122, s98, v146
    v_dot2_f32_bf16 v147, v122, s99, v147
    v_dot2_f32_bf16 v144, v124, s98, v144
    v_dot2_f32_bf16 v145, v124, s99, v145
    v_dot2_f32_bf16 v146, v126, s98, v146
    v_dot2_f32_bf16 v147, v126, s99, v147
    v_dot2_f32_bf16 v144, v128, s98, v144
    v_dot2_f32_bf16 v145, v128, s99, v145
    v_dot2_f32_bf16 v146, v130, s98, v146
    v_dot2_f32_bf16 v147, v130, s99, v147
    v_dot2_f32_bf16 v144, v132, s98, v144
    v_dot2_f32_bf16 v145, v132, s99, v145
    v_dot2_f32_bf16 v146, v134, s98, v146
    v_dot2_f32_bf16 v147, v134, s99, v147
    v_dot2_f32_bf16 v144, v136, s98, v144
    v_dot2_f32_bf16 v145, v136, s99, v145
    v_dot2_f32_bf16 v146, v138, s98, v146
    v_dot2_f32_bf16 v147, v138, s99, v147
    v_dot2_f32_bf16 v144, v140, s98, v144
    v_dot2_f32_bf16 v145, v140, s99, v145
    v_dot2_f32_bf16 v146, v142, s98, v146
    v_dot2_f32_bf16 v147, v142, s99, v147
    v_mov_b32 v148, v144
    v_mov_b32 v149, v145
    v_mov_b32 v150, v146
    v_mov_b32 v151, v147
    v_permlane16_swap_b32 v144, v148
    v_permlane16_swap_b32 v145, v149
    v_permlane16_swap_b32 v146, v150
    v_permlane16_swap_b32 v147, v151
    v_add_f32 v144, v144, v148
    v_add_f32 v145, v145, v149
    v_add_f32 v146, v146, v150
    v_add_f32 v147, v147, v151
    v_mov_b32 v148, v144
    v_mov_b32 v149, v145
    v_mov_b32 v150, v146
    v_mov_b32 v151, v147
    v_permlane32_swap_b32 v144, v148
    v_permlane32_swap_b32 v145, v149
    v_permlane32_swap_b32 v146, v150
    v_permlane32_swap_b32 v147, v151
    v_add_f32 v144, v144, v148
    v_add_f32 v145, v145, v149
    v_add_f32 v146, v146, v150
    v_add_f32 v147, v147, v151
    v_lshlrev_b32 v152, 16, v100
    v_and_b32 v153, 0xffff0000, v100
    v_lshlrev_b32 v154, 16, v101
    v_and_b32 v155, 0xffff0000, v101
    v_lshlrev_b32 v156, 16, v104
    v_and_b32 v157, 0xffff0000, v104
    v_lshlrev_b32 v158, 16, v106
    v_and_b32 v159, 0xffff0000, v106
    v_fmac_f32 v152, v156, v144
    v_fmac_f32 v153, v157, v145
    v_fmac_f32 v154, v158, v146
    v_fmac_f32 v155, v159, v147
    v_lshlrev_b32 v156, 16, v108
    v_and_b32 v157, 0xffff0000, v108
    v_lshlrev_b32 v158, 16, v110
    v_and_b32 v159, 0xffff0000, v110
    s_mov_b32 s59, 20000
L_poll_43:
    buffer_load_dwordx4 v[176:179], v11, s[8:11], s72 offen sc1
    buffer_load_dwordx4 v[180:183], v11, s[8:11], s72 offen offset:1024 sc1
    buffer_load_dwordx4 v[184:187], v11, s[8:11], s72 offen offset:2048 sc1
    buffer_load_dwordx4 v[188:191], v11, s[8:11], s72 offen offset:3072 sc1
    buffer_load_dwordx4 v[192:195], v11, s[8:11], s73 offen sc1
    buffer_load_dwordx4 v[196:199], v11, s[8:11], s73 offen offset:1024 sc1
    s_waitcnt vmcnt(0)
    v_mov_b32 v10, s6
    v_cndmask_b32 v197, v10, v197, s[100:101]
    v_cndmask_b32 v199, v10, v199, s[100:101]
    v_cndmask_b32 v196, 0, v196, s[100:101]
    v_cndmask_b32 v198, 0, v198, s[100:101]
    v_xor_b32 v10, s6, v177
    v_bitop3_b32 v10, v10, v179, s6 bitop3:0xf6
    v_bitop3_b32 v10, v10, v181, s6 bitop3:0xf6
    v_bitop3_b32 v10, v10, v183, s6 bitop3:0xf6
    v_bitop3_b32 v10, v10, v185, s6 bitop3:0xf6
    v_bitop3_b32 v10, v10, v187, s6 bitop3:0xf6
    v_bitop3_b32 v10, v10, v189, s6 bitop3:0xf6
    v_bitop3_b32 v10, v10, v191, s6 bitop3:0xf6
    v_bitop3_b32 v10, v10, v193, s6 bitop3:0xf6
    v_bitop3_b32 v10, v10, v195, s6 bitop3:0xf6
    v_bitop3_b32 v10, v10, v197, s6 bitop3:0xf6
    v_bitop3_b32 v10, v10, v199, s6 bitop3:0xf6
    v_cmp_ne_u32 vcc, 0, v10
    s_cbranch_vccz L_ok_44
    s_sub_u32 s59, s59, 1
    s_cbranch_scc1 L_fail_10
    s_sleep 1
    s_branch L_poll_43
L_ok_44:
    v_dot2_f32_bf16 v144, v176, s98, 0
    v_dot2_f32_bf16 v145, v176, s99, 0
    v_dot2_f32_bf16 v146, v178, s98, 0
    v_dot2_f32_bf16 v147, v178, s99, 0
    v_dot2_f32_bf16 v144, v180, s98, v144
    v_dot2_f32_bf16 v145, v180, s99, v145
    v_dot2_f32_bf16 v146, v182, s98, v146
    v_dot2_f32_bf16 v147, v182, s99, v147
    v_dot2_f32_bf16 v144, v184, s98, v144
    v_dot2_f32_bf16 v145, v184, s99, v145
    v_dot2_f32_bf16 v146, v186, s98, v146
    v_dot2_f32_bf16 v147, v186, s99, v147
    v_dot2_f32_bf16 v144, v188, s98, v144
    v_dot2_f32_bf16 v145, v188, s99, v145
    v_dot2_f32_bf16 v146, v190, s98, v146
    v_dot2_f32_bf16 v147, v190, s99, v147
    v_dot2_f32_bf16 v144, v192, s98, v144
    v_dot2_f32_bf16 v145, v192, s99, v145
    v_dot2_f32_bf16 v146, v194, s98, v146
    v_dot2_f32_bf16 v147, v194, s99, v147
    v_dot2_f32_bf16 v144, v196, s98, v144
    v_dot2_f32_bf16 v145, v196, s99, v145
    v_dot2_f32_bf16 v146, v198, s98, v146
    v_dot2_f32_bf16 v147, v198, s99, v147
    v_mov_b32 v148, v144
    v_mov_b32 v149, v145
    v_mov_b32 v150, v146
    v_mov_b32 v151, v147
    v_permlane16_swap_b32 v144, v148
    v_permlane16_swap_b32 v145, v149
    v_permlane16_swap_b32 v146, v150
    v_permlane16_swap_b32 v147, v151
    v_add_f32 v144, v144, v148
    v_add_f32 v145, v145, v149
    v_add_f32 v146, v146, v150
    v_add_f32 v147, v147, v151
    v_mov_b32 v148, v144
    v_mov_b32 v149, v145
    v_mov_b32 v150, v146
    v_mov_b32 v151, v147
    v_permlane32_swap_b32 v144, v148
    v_permlane32_swap_b32 v145, v149
    v_permlane32_swap_b32 v146, v150
    v_permlane32_swap_b32 v147, v151
    v_add_f32 v144, v144, v148
    v_add_f32 v145, v145, v149
    v_add_f32 v146, v146, v150
    v_add_f32 v147, v147, v151
    v_fmac_f32 v152, v156, v144
    v_fmac_f32 v153, v157, v145
    v_fmac_f32 v154, v158, v146
    v_fmac_f32 v155, v159, v147
    v_cvt_pk_bf16_f32 v152, v152, v153
    v_cvt_pk_bf16_f32 v153, v154, v155
    s_mov_b64 exec, 0xffff
    buffer_store_dwordx2 v[152:153], v6, s[12:15], s70 offen
    s_mov_b64 exec, -1
    s_branch L_exit
L_idle:
    s_waitcnt vmcnt(0)
    s_barrier
    s_cmp_lg_u32 s5, 0
    s_cbranch_scc1 L_nofl_45
    s_mov_b64 exec, 0xffff
    buffer_store_dwordx2 v[238:239], v95, s[8:11], s71 offen sc1
    s_mov_b64 exec, -1
L_nofl_45:
    s_cmp_eq_u32 s2, 95
    s_cbranch_scc0 L_exit
    s_cmp_lg_u32 s5, 0
    s_cbranch_scc1 L_exit
    v_and_b32 v5, 7, v1
    v_lshlrev_b32 v5, 15, v5
    v_add_u32 v5, 2040, v5
    s_mov_b32 s53, 393216
    s_mov_b32 s59, 20000
L_poll_46:
    buffer_load_dwordx2 v[6:7], v5, s[8:11], s53 offen sc1
    s_waitcnt vmcnt(0)
    v_xor_b32 v8, s6, v7
    v_cmp_ne_u32 vcc, 0, v8
    s_cbranch_vccz L_ok_47
    s_sub_u32 s59, s59, 1
    s_cbranch_scc1 L_fail_11
    s_sleep 8
    s_branch L_poll_46
L_ok_47:
    s_add_u32 s53, s7, 1
    v_mov_b32 v6, s53
    v_mov_b32 v5, 0
    s_mov_b64 exec, 1
    buffer_store_dword v6, v5, s[8:11], 0 offen sc1
    s_mov_b64 exec, -1
    s_branch L_exit
L_fail_1:
    s_mov_b32 s53, 1
    s_branch L_fail
L_fail_2:
    s_mov_b32 s53, 2
    s_branch L_fail
L_fail_3:
    s_mov_b32 s53, 3
    s_branch L_fail
L_fail_4:
    s_mov_b32 s53, 4
    s_branch L_fail
L_fail_5:
    s_mov_b32 s53, 5
    s_branch L_fail
L_fail_6:
    s_mov_b32 s53, 6
    s_branch L_fail
L_fail_7:
    s_mov_b32 s53, 7
    s_branch L_fail
L_fail_12:
    s_mov_b32 s53, 12
    s_branch L_fail
L_fail_9:
    s_mov_b32 s53, 9
    s_branch L_fail
L_fail_10:
    s_mov_b32 s53, 10
    s_branch L_fail
L_fail_11:
    s_mov_b32 s53, 11
    s_branch L_fail
L_fail:
    s_waitcnt vmcnt(0) lgkmcnt(0)
    s_mov_b32 s12, s40
    s_mov_b32 s13, s41
    s_mov_b32 s14, 256
    s_mov_b32 s15, 0x00020000
    s_mov_b64 exec, 1
    s_lshl_b32 s54, s53, 2
    v_mov_b32 v5, s54
    v_mov_b32 v6, s2
    v_add_u32 v6, 1000, v6
    buffer_store_dword v6, v5, s[12:15], 0 offen
    s_mov_b64 exec, -1
L_exit:
L_end:
    s_endpgm
.section .rodata,"a"
.p2align 6
.amdhsa_kernel adaLN_cond__compressed_kv_cla__dense_activation_relu__decode_kernel
  .amdhsa_next_free_vgpr 256
  .amdhsa_next_free_sgpr 102
  .amdhsa_accum_offset 256
  .amdhsa_group_segment_fixed_size 0
  .amdhsa_kernarg_size 112
  .amdhsa_user_sgpr_count 2
  .amdhsa_user_sgpr_kernarg_segment_ptr 1
  .amdhsa_system_sgpr_workgroup_id_x 1
.end_amdhsa_kernel
```
